```python
import torch

def _softmax(x, axis=-1):
    return torch.softmax(x, dim=axis)
def _gelu(x):
    return torch.nn.functional.gelu(x, approximate="tanh")
def _silu(x):
    return torch.nn.functional.silu(x)
def _sigmoid(x):
    return torch.sigmoid(x)
def _layernorm(x, axis=-1, eps=1e-5):
    m = x.mean(dim=axis, keepdim=True)
    v = x.var(dim=axis, keepdim=True, unbiased=False)
    return (x - m) / torch.sqrt(v + eps)
def _scatter_add(tgt, idx, src, axis=0):
    return tgt.clone().index_add_(axis, idx, src)
def _segment_sum(src, seg, n):
    out = torch.zeros((n,) + src.shape[1:], dtype=src.dtype)
    return out.index_add_(0, seg, src)
def _pad(x, pw):
    flat = tuple(v for pair in reversed(pw) for v in pair)
    return torch.nn.functional.pad(x, flat)

kernel_name = 'standalone__cheap_equivariant_egnn__graph'

def setup_inputs():

    _w = (lambda a: (lambda t: t.to(torch.bfloat16) if t.is_floating_point() else t)(torch.as_tensor(a)))
    N, deg, D, De = 10000, 64, 64, max(0, 1)
    E = N * deg
    return {
        "h": _w((lambda *s: torch.randn(*s, dtype=torch.bfloat16) * 0.1)(N, D)),
        "pos": _w((lambda *s: torch.randn(*s, dtype=torch.bfloat16) * 0.8)(N, 3)),
        "e_attr": _w((lambda *s: torch.randn(*s, dtype=torch.bfloat16) * 0.8)(E, De)),
        "src": _w((lambda lo, hi, *s: torch.randint(lo, hi, s))(0, N, E).to(torch.int64)),
        "dst": _w((lambda lo, hi, *s: torch.randint(lo, hi, s))(0, N, E).to(torch.int64)),
        "w_e": _w(0.1 * (lambda *s: torch.randn(*s, dtype=torch.bfloat16) * 0.8)(2 * D + 1 + De, D)),
        "w_x": _w(0.1 * (lambda *s: torch.randn(*s, dtype=torch.bfloat16) * 0.1)(D, 1)),
        "w_h": _w(0.1 * (lambda *s: torch.randn(*s, dtype=torch.bfloat16) * 0.1)(2 * D, D)),
    }

def reference(h, pos, e_attr, src, dst, w_e, w_x, w_h):
    N, D = h.shape[0], h.shape[1]
    diff = pos[dst] - pos[src]
    dist2 = torch.sum(diff * diff, axis=-1, keepdims=True)
    e_in = torch.concatenate([h[dst], h[src], dist2, e_attr], axis=-1)
    m_ij = _silu(e_in @ w_e)
    coord_scale = m_ij @ w_x
    pos_new = pos + _segment_sum(diff * coord_scale, dst, N)
    m_i = _segment_sum(m_ij, dst, N)
    h_new = h + _silu(torch.concatenate([h, m_i], axis=-1) @ w_h)
    return h_new, pos_new
```

```asm
; @launch grid=(256,1,1) block=(1024,1,1) lds=163840
.amdgcn_target "amdgcn-amd-amdhsa--gfx950"
.text
.globl standalone__cheap_equivariant_egnn__graph_kernel
.p2align 12
.p2align 8
.type standalone__cheap_equivariant_egnn__graph_kernel,@function
standalone__cheap_equivariant_egnn__graph_kernel:
    s_cmp_ge_u32 s2, 256
    s_cbranch_scc1 L_end
    s_load_dwordx16 s[40:55], s[0:1], 0
    s_load_dwordx2 s[14:15], s[0:1], 80
    s_load_dwordx2 s[12:13], s[0:1], 64
    v_lshrrev_b32 v1, 6, v0
    s_nop 0
    v_readfirstlane_b32 s3, v1
    v_and_b32 v3, 63, v0
    v_lshlrev_b32 v2, 4, v3
    s_lshr_b32 s19, s2, 3
    s_mov_b32 s39, 1568768
    s_mov_b32 s62, 0x3fb8aa3b
    v_mov_b32 v127, 4
    s_cmp_ge_u32 s3, 10
    s_cbranch_scc1 L_h0
    v_lshlrev_b32 v1, 4, v0
    s_mul_i32 s56, s2, 10000
    v_add_u32 v92, s56, v1
    v_lshrrev_b32 v93, 1, v92
    v_cmp_gt_u32 vcc, 625, v0
    s_nop 0
    s_mov_b64 s[64:65], vcc
    s_cmp_lg_u32 s3, 0
    s_cbranch_scc1 L_nz
    s_getpc_b64 s[60:61]
L_pc:
    s_mul_i32 s58, s19, 640
    v_lshl_add_u32 v16, v3, 7, s58
    v_min_u32 v16, L_end-L_pc-896, v16
    s_mov_b64 exec, 31
    global_load_dword v54, v16, s[60:61] offset:896
    s_mov_b64 exec, -1
    v_mov_b64 v[8:9], 0
    v_mov_b64 v[10:11], 0
    ds_write_b128 v2, v[8:11] offset:2560
    s_mov_b32 exec_hi, 0xfffff
    ds_write_b128 v2, v[8:11] offset:1024
    s_mov_b32 exec_hi, -1
L_nz:
    s_mov_b64 exec, vcc
    s_waitcnt lgkmcnt(0)
    global_load_dwordx4 v[44:47], v92, s[48:49] nt
    s_load_dword s39, s[14:15], s39
    s_barrier
    global_load_dwordx4 v[48:51], v92, s[46:47] nt
    global_load_dwordx2 v[52:53], v93, s[44:45] nt
    s_mov_b64 exec, -1
    s_branch L_edge
L_h0:
    s_cmp_eq_u32 s3, 10
    s_cbranch_scc1 L_wb0
    s_cmp_eq_u32 s3, 11
    s_cbranch_scc1 L_lut
    v_and_b32 v93, 0xff, v0
    v_lshlrev_b32 v92, 18, v93
    v_add_u32 v92, 0x33008000, v92
    v_lshlrev_b32 v93, 3, v93
    v_add_u32 v93, 90112, v93
    v_add_u32 v94, 0x10000, v93
    v_add_u32 v96, 0x0, v92
    v_add_u32 v97, 0x10000, v92
    v_add_u32 v98, 0x20000, v92
    v_add_u32 v99, 0x30000, v92
    v_pk_mul_f32 v[96:97], v[96:97], s[62:63] op_sel_hi:[1,0]
    v_pk_mul_f32 v[98:99], v[98:99], s[62:63] op_sel_hi:[1,0]
    v_exp_f32 v100, -v96
    v_exp_f32 v101, -v97
    v_exp_f32 v102, -v98
    v_exp_f32 v103, -v99
    v_pk_add_f32 v[104:105], v[100:101], 1.0 op_sel_hi:[1,0]
    v_pk_add_f32 v[106:107], v[102:103], 1.0 op_sel_hi:[1,0]
    v_rcp_f32 v104, v104
    v_rcp_f32 v105, v105
    v_rcp_f32 v106, v106
    v_rcp_f32 v107, v107
    v_pk_mul_f32 v[96:97], v[96:97], v[104:105]
    v_pk_mul_f32 v[98:99], v[98:99], v[106:107]
    v_pk_mul_f32 v[100:101], v[96:97], v[100:101] neg_lo:[1,0] neg_hi:[1,0]
    v_pk_mul_f32 v[102:103], v[98:99], v[102:103] neg_lo:[1,0] neg_hi:[1,0]
    v_cvt_pk_bf16_f32 v96, v96, v97
    v_cvt_pk_bf16_f32 v97, v98, v99
    v_cvt_pk_bf16_f32 v100, v100, v101
    v_cvt_pk_bf16_f32 v101, v102, v103
    ds_write_b64 v93, v[96:97] offset:0
    ds_write_b64 v94, v[100:101] offset:0
L_lut:
    s_and_b32 s16, s2, 7
    s_lshl_b32 s16, s16, 5
    s_add_u32 s16, s16, s19
    s_mul_i32 s17, s16, 625
    s_add_u32 s18, s17, 640
    s_add_u32 s17, s17, 15
    s_lshr_b32 s17, s17, 4
    s_lshr_b32 s18, s18, 4
    s_sub_u32 s18, s18, s17
    s_mov_b32 s26, 7147520
    s_mov_b32 s27, 0x20000
    s_mov_b32 s10, 60000
    s_mov_b32 s11, s27
    v_mul_u32_u24 v1, 12, v3
    s_sub_u32 s64, s3, 12
    s_mul_i32 s56, s64, 15360
    s_waitcnt lgkmcnt(0)
    s_load_dword s39, s[14:15], s39
    s_barrier
    s_mov_b32 s24, s14
    s_and_b32 s25, s15, 0xffff
    s_mov_b32 s8, s42
    s_and_b32 s9, s43, 0xffff
    s_mov_b32 s20, s14
    s_or_b32 s21, s25, 0x80000000
    s_cmp_eq_u32 s3, 11
    s_cbranch_scc1 L_wa0
    s_cmp_eq_u32 s3, 14
    s_cbranch_scc1 L_j14
    s_cmp_lg_u32 s3, 13
    s_cbranch_scc1 L_pos
    v_lshlrev_b32 v5, 1, v3
    s_add_u32 s60, s50, 16384
    s_addc_u32 s61, s51, 0
    global_load_ushort v108, v5, s[60:61]
    global_load_ushort v109, v5, s[60:61] offset:128
    global_load_ushort v110, v5, s[52:53]
    s_branch L_pos
L_j14:
    v_add_u32 v4, s17, v3
    v_mul_u32_u24 v4, 6, v4
    buffer_load_ushort v108, v4, s[8:11], 0 offen
    buffer_load_ushort v110, v4, s[8:11], 0 offen offset:2
    buffer_load_ushort v109, v4, s[8:11], 0 offen offset:4
L_pos:
    buffer_load_dwordx3 v[12:14], v1, s[8:11], s56 offen offset:0
    buffer_load_dwordx3 v[16:18], v1, s[8:11], s56 offen offset:768
    buffer_load_dwordx3 v[20:22], v1, s[8:11], s56 offen offset:1536
    buffer_load_dwordx3 v[24:26], v1, s[8:11], s56 offen offset:2304
    buffer_load_dwordx3 v[28:30], v1, s[8:11], s56 offen offset:3072
    s_addk_i32 s56, 3840
    buffer_load_dwordx3 v[32:34], v1, s[8:11], s56 offen offset:0
    buffer_load_dwordx3 v[36:38], v1, s[8:11], s56 offen offset:768
    buffer_load_dwordx3 v[40:42], v1, s[8:11], s56 offen offset:1536
    buffer_load_dwordx3 v[44:46], v1, s[8:11], s56 offen offset:2304
    buffer_load_dwordx3 v[48:50], v1, s[8:11], s56 offen offset:3072
    s_addk_i32 s56, 3840
    buffer_load_dwordx3 v[52:54], v1, s[8:11], s56 offen offset:0
    buffer_load_dwordx3 v[56:58], v1, s[8:11], s56 offen offset:768
    buffer_load_dwordx3 v[60:62], v1, s[8:11], s56 offen offset:1536
    buffer_load_dwordx3 v[64:66], v1, s[8:11], s56 offen offset:2304
    buffer_load_dwordx3 v[68:70], v1, s[8:11], s56 offen offset:3072
    s_addk_i32 s56, 3840
    buffer_load_dwordx3 v[72:74], v1, s[8:11], s56 offen offset:0
    buffer_load_dwordx3 v[76:78], v1, s[8:11], s56 offen offset:768
    buffer_load_dwordx3 v[80:82], v1, s[8:11], s56 offen offset:1536
    buffer_load_dwordx3 v[84:86], v1, s[8:11], s56 offen offset:2304
    buffer_load_dwordx3 v[88:90], v1, s[8:11], s56 offen offset:3072
    s_mov_b64 exec, 1
    ds_add_u32 v127, v127 offset:1800
    s_mov_b64 exec, -1
    s_branch L_pos1
L_edge:
    s_mov_b32 s24, s14
    s_and_b32 s25, s15, 0xffff
    s_mov_b32 s26, 7147520
    s_mov_b32 s27, 0x20000
    s_mov_b32 s58, 214749
    s_movk_i32 s59, 0x3f0
    s_mov_b32 s63, 0xffff0000
    s_mul_i32 s66, s2, 20480
    s_add_u32 s66, s66, 1900544
    s_add_u32 s67, s66, 10240
    s_waitcnt lgkmcnt(0)
    s_mul_i32 s39, s39, 0x9e3779b1
    s_add_u32 s39, s39, 0x7f4a7c15
    s_and_b32 s70, s39, 0xfc0f
    s_bfe_u32 s71, s39, 0x20004
    s_and_b32 s56, s39, 0xffff0000
    s_or_b32 s71, s71, s56
    v_mov_b32 v62, 8
    v_mov_b32 v63, s70
    s_setprio 2
    s_waitcnt vmcnt(2)
    v_mul_u32_u24 v54, s58, v44
    v_mul_u32_u24 v55, s58, v45
    v_mul_u32_u24 v56, s58, v46
    v_mul_u32_u24 v57, s58, v47
    v_lshrrev_b32 v54, 21, v54
    v_lshrrev_b32 v55, 21, v55
    v_lshrrev_b32 v56, 21, v56
    v_lshrrev_b32 v57, 21, v57
    v_and_b32 v54, 0x3fc, v54
    v_and_b32 v55, 0x3fc, v55
    v_and_b32 v56, 0x3fc, v56
    v_and_b32 v57, 0x3fc, v57
    s_mov_b64 exec, s[64:65]
    ds_add_rtn_u32 v58, v54, v62 offset:2560
    ds_add_rtn_u32 v59, v55, v62 offset:2560
    ds_add_rtn_u32 v60, v56, v62 offset:2560
    ds_add_rtn_u32 v61, v57, v62 offset:2560
    s_mov_b64 exec, 1
    ds_add_u32 v127, v127 offset:1796
    s_mov_b64 exec, -1
    v_lshlrev_b32 v44, 4, v44
    v_lshlrev_b32 v45, 4, v45
    v_lshlrev_b32 v46, 4, v46
    v_lshlrev_b32 v47, 4, v47
    v_and_or_b32 v64, v44, s59, v63
    v_and_or_b32 v66, v45, s59, v63
    v_and_or_b32 v68, v46, s59, v63
    v_and_or_b32 v70, v47, s59, v63
    s_cmp_lg_u32 s3, 9
    s_cbranch_scc1 L_nd
    v_mov_b32 v72, s70
    v_mov_b32 v73, s71
    v_lshlrev_b32 v74, 3, v3
    s_mov_b64 exec, 0xfff
    ds_write_b64 v74, v[72:73] offset:24608
    s_mov_b64 exec, -1
L_nd:
L_sp1:
    ds_read_b32 v72, v127 offset:1796
    ds_read_b128 v[44:47], v2 offset:2560
    s_waitcnt lgkmcnt(1)
    v_cmp_ne_u32 vcc, 40, v72
    s_cbranch_vccnz L_sp1
    s_waitcnt lgkmcnt(0)
    v_add3_u32 v72, v44, v45, v46
    v_add_u32 v73, v72, v47
    s_nop 1
    v_add_u32_dpp v73, v73, v73 row_shr:1 row_mask:0xf bank_mask:0xf
    s_nop 1
    v_add_u32_dpp v73, v73, v73 row_shr:2 row_mask:0xf bank_mask:0xf
    s_nop 1
    v_add_u32_dpp v73, v73, v73 row_shr:4 row_mask:0xf bank_mask:0xf
    s_nop 1
    v_add_u32_dpp v73, v73, v73 row_shr:8 row_mask:0xf bank_mask:0xf
    s_nop 1
    v_add_u32_dpp v73, v73, v73 row_bcast:15 row_mask:0xa bank_mask:0xf
    s_nop 1
    v_add_u32_dpp v73, v73, v73 row_bcast:31 row_mask:0xc bank_mask:0xf
    v_sub_u32 v79, v73, v47
    v_sub_u32 v78, v79, v46
    v_sub_u32 v76, v79, v72
    v_sub_u32 v77, v78, v45
    ds_write_b128 v2, v[76:79] offset:3584
    s_mov_b64 exec, s[64:65]
    ds_read_b32 v54, v54 offset:3584
    ds_read_b32 v55, v55 offset:3584
    ds_read_b32 v56, v56 offset:3584
    ds_read_b32 v57, v57 offset:3584
    s_waitcnt vmcnt(1)
    v_lshl_or_b32 v65, v48, 2, s71
    v_lshl_or_b32 v67, v49, 2, s71
    v_lshl_or_b32 v69, v50, 2, s71
    v_lshl_or_b32 v71, v51, 2, s71
    s_waitcnt vmcnt(0)
    v_lshl_or_b32 v64, v52, 16, v64
    v_and_or_b32 v66, v52, s63, v66
    v_lshl_or_b32 v68, v53, 16, v68
    v_and_or_b32 v70, v53, s63, v70
    s_waitcnt lgkmcnt(0)
    v_add_u32 v54, v54, v58
    v_add_u32 v55, v55, v59
    v_add_u32 v56, v56, v60
    v_add_u32 v57, v57, v61
    ds_write_b64 v54, v[64:65] offset:4608
    ds_write_b64 v55, v[66:67] offset:4608
    ds_write_b64 v56, v[68:69] offset:4608
    ds_write_b64 v57, v[70:71] offset:4608
    s_mov_b64 exec, 1
    ds_add_u32 v127, v127 offset:1800
    s_mov_b64 exec, -1
    s_cmp_lg_u32 s3, 0
    s_cbranch_scc1 L_nogr
    s_lshl_b32 s56, s2, 10
    s_add_u32 s56, s56, 1572864
    s_and_b32 s57, s39, 0xffc08007
    v_min_u32 v44, 504, v44
    v_min_u32 v45, 504, v45
    v_min_u32 v46, 504, v46
    v_min_u32 v47, 504, v47
    v_lshlrev_b32 v44, 13, v44
    v_lshlrev_b32 v45, 13, v45
    v_lshlrev_b32 v46, 13, v46
    v_lshlrev_b32 v47, 13, v47
    v_or3_b32 v76, v76, v44, s57
    v_or3_b32 v77, v77, v45, s57
    v_or3_b32 v78, v78, v46, s57
    v_or3_b32 v79, v79, v47, s57
    buffer_store_dwordx4 v[76:79], v2, s[24:27], s56 offen sc1
L_nogr:
L_sp2:
    ds_read_b32 v72, v127 offset:1800
    s_waitcnt lgkmcnt(0)
    v_cmp_ne_u32 vcc, 60, v72
    s_cbranch_vccnz L_sp2
    ds_read_b128 v[84:87], v1 offset:4608
    ds_read_b128 v[88:91], v1 offset:14848
    v_cmp_gt_u32 vcc, 616, v0
    s_waitcnt lgkmcnt(1)
    buffer_store_dwordx4 v[84:87], v1, s[24:27], s66 offen sc1
    s_mov_b64 exec, vcc
    s_waitcnt lgkmcnt(0)
    buffer_store_dwordx4 v[88:91], v1, s[24:27], s67 offen sc1
    s_mov_b64 exec, 1
    ds_add_u32 v127, v127 offset:1804
    s_mov_b64 exec, -1
    s_setprio 0
    s_and_b32 s16, s2, 7
    s_lshl_b32 s16, s16, 5
    s_add_u32 s16, s16, s19
    s_mul_i32 s17, s16, 625
    s_add_u32 s18, s17, 640
    s_add_u32 s17, s17, 15
    s_lshr_b32 s17, s17, 4
    s_lshr_b32 s18, s18, 4
    s_sub_u32 s18, s18, s17
    s_mov_b32 s24, s14
    s_and_b32 s25, s15, 0xffff
    s_mov_b32 s8, s42
    s_and_b32 s9, s43, 0xffff
    s_mov_b32 s20, s14
    s_or_b32 s21, s25, 0x80000000
L_x:
    v_bfe_u32 v96, v0, 2, 5
    s_lshr_b32 s56, s3, 1
    v_lshl_add_u32 v97, v96, 3, s56
    v_lshlrev_b32 v113, 10, v97
    s_and_b32 s69, s16, 0xfc
    s_lshl_b32 s69, s69, 2
    s_add_u32 s69, s69, 1572864
L_x1:
    v_and_b32 v92, 3, v3
    v_lshlrev_b32 v115, 4, v92
    s_mov_b32 s57, 20480
    v_mad_u32_u24 v114, v97, s57, v115
    v_lshlrev_b32 v115, 1, v92
    s_mov_b32 s36, 82432
    v_and_b32 v98, 0xf0, v2
    v_add_u32 v98, s36, v98
    ds_read_b128 v[120:123], v98 offset:7680
    v_lshrrev_b32 v93, 4, v0
    v_lshl_add_u32 v94, v0, 4, s36
    v_subrev_u32 v96, 30, v93
    s_mov_b32 s61, 0x800080
    v_mul_lo_u32 v96, v96, s61
    v_add_u32 v97, 0x30803080, v96
    s_waitcnt lgkmcnt(0)
    v_add_u32 v100, v97, v120
    v_add_u32 v101, v97, v121
    v_add_u32 v102, v97, v122
    v_add_u32 v103, v97, v123
    ds_write_b128 v94, v[100:103] offset:24576
    v_sub_u32 v98, 32, v93
    v_ashrrev_i32 v98, 31, v98
    v_and_b32 v97, 0x1e801e80, v98
    s_mov_b32 s61, 0x50805080
    v_add3_u32 v97, v97, v96, s61
    v_and_b32 v98, 15872, v98
    v_add_u32 v98, v98, v94
    v_add_u32 v104, v97, v120
    v_add_u32 v105, v97, v121
    v_add_u32 v106, v97, v122
    v_add_u32 v107, v97, v123
    ds_write_b128 v98, v[104:107] offset:40960
    v_sub_u32 v98, 29, v93
    v_ashrrev_i32 v98, 31, v98
    v_and_b32 v97, 0x10801080, v98
    v_add_u32 v97, v97, v96
    v_and_b32 v98, 8192, v98
    v_add_u32 v98, v98, v94
    v_add_u32 v120, v97, v120
    v_add_u32 v121, v97, v121
    v_add_u32 v122, v97, v122
    v_add_u32 v123, v97, v123
    ds_write_b128 v98, v[120:123]
    s_mov_b32 s10, 60000
    s_mov_b32 s11, 0x20000
    s_mov_b32 s22, 1280000
    s_mov_b32 s23, 0x00c00000
    s_cmp_lt_u32 s3, 10
    s_cbranch_scc1 L_e2
    s_cmp_gt_u32 s3, 11
    s_cbranch_scc1 L_y1
    s_cmp_eq_u32 s3, 11
    s_cbranch_scc1 L_wa
    s_lshl_b32 s56, s2, 7
    s_add_u32 s56, s56, 1835008
    s_not_b32 s64, s39
    v_mov_b32 v92, s39
    v_mov_b32 v93, s64
    v_mov_b32 v94, s39
    v_mov_b32 v95, s64
    s_mov_b64 exec, 0xff
    s_waitcnt vmcnt(0)
    buffer_store_dwordx4 v[92:95], v2, s[24:27], s56 offen sc1
    s_mov_b64 exec, -1
    s_branch L_w4
L_e2:
    s_mov_b64 exec, 0
    s_cmp_eq_u32 s3, 0
    s_cbranch_scc1 L_ic0
    s_cmp_eq_u32 s3, 1
    s_cbranch_scc1 L_ic1
    s_cmp_eq_u32 s3, 2
    s_cbranch_scc1 L_ic2
    s_cmp_eq_u32 s3, 3
    s_cbranch_scc1 L_ic3
    s_cmp_eq_u32 s3, 4
    s_cbranch_scc1 L_ic4
    s_cmp_eq_u32 s3, 5
    s_cbranch_scc1 L_ic5
    s_cmp_eq_u32 s3, 6
    s_cbranch_scc1 L_ic6
    s_cmp_eq_u32 s3, 7
    s_cbranch_scc1 L_ic7
    s_cmp_eq_u32 s3, 8
    s_cbranch_scc1 L_ic8
    s_cmp_eq_u32 s3, 9
    s_cbranch_scc1 L_ic9
L_icr:
    s_mov_b64 exec, -1
    s_cmp_lg_u32 s3, 0
    s_cbranch_scc1 L_sp8e
    s_waitcnt vmcnt(1)
    ds_write_b32 v127, v127 offset:1820
L_sp8e:
    ds_read_b32 v99, v127 offset:1820
    s_waitcnt lgkmcnt(0)
    v_cmp_ne_u32 vcc, 4, v99
    s_cbranch_vccnz L_sp8e
    buffer_load_dwordx4 v[108:111], v113, s[24:27], s69 offen sc1
    s_branch L_y1
L_wa0:
    s_setprio 1
    v_lshrrev_b32 v4, 5, v3
    v_and_b32 v5, 31, v3
    v_lshlrev_b32 v5, 2, v5
    v_lshl_add_u32 v5, v4, 10, v5
    v_add_u32 v1, 4096, v5
    global_load_dword v60, v5, s[50:51] offset:0
    global_load_dword v61, v5, s[50:51] offset:128
    global_load_dword v62, v5, s[50:51] offset:256
    global_load_dword v63, v5, s[50:51] offset:384
    global_load_dword v64, v5, s[50:51] offset:512
    global_load_dword v65, v5, s[50:51] offset:640
    global_load_dword v66, v5, s[50:51] offset:768
    global_load_dword v67, v5, s[50:51] offset:896
    global_load_dword v68, v5, s[50:51] offset:2048
    global_load_dword v69, v5, s[50:51] offset:2176
    global_load_dword v70, v5, s[50:51] offset:2304
    global_load_dword v71, v5, s[50:51] offset:2432
    global_load_dword v72, v5, s[50:51] offset:2560
    global_load_dword v73, v5, s[50:51] offset:2688
    global_load_dword v74, v5, s[50:51] offset:2816
    global_load_dword v75, v5, s[50:51] offset:2944
    global_load_dword v76, v1, s[50:51] offset:0
    global_load_dword v77, v1, s[50:51] offset:128
    global_load_dword v78, v1, s[50:51] offset:256
    global_load_dword v79, v1, s[50:51] offset:384
    global_load_dword v80, v1, s[50:51] offset:512
    global_load_dword v81, v1, s[50:51] offset:640
    global_load_dword v82, v1, s[50:51] offset:768
    global_load_dword v83, v1, s[50:51] offset:896
    global_load_dword v84, v1, s[50:51] offset:2048
    global_load_dword v85, v1, s[50:51] offset:2176
    global_load_dword v86, v1, s[50:51] offset:2304
    global_load_dword v87, v1, s[50:51] offset:2432
    global_load_dword v88, v1, s[50:51] offset:2560
    global_load_dword v89, v1, s[50:51] offset:2688
    global_load_dword v90, v1, s[50:51] offset:2816
    global_load_dword v91, v1, s[50:51] offset:2944
    s_mov_b64 exec, 1
    ds_add_u32 v127, v127 offset:1800
    s_mov_b64 exec, -1
    s_waitcnt lgkmcnt(0)
    s_mul_i32 s39, s39, 0x9e3779b1
    s_add_u32 s39, s39, 0x7f4a7c15
    s_and_b32 s70, s39, 0xfc0f
    s_bfe_u32 s71, s39, 0x20004
    s_and_b32 s56, s39, 0xffff0000
    s_or_b32 s71, s71, s56
    s_branch L_x
.p2align 12
L_wb0:
    s_and_b32 s16, s2, 7
    s_lshl_b32 s16, s16, 5
    s_add_u32 s16, s16, s19
    s_mul_i32 s17, s16, 625
    s_add_u32 s18, s17, 640
    s_add_u32 s17, s17, 15
    s_lshr_b32 s17, s17, 4
    s_lshr_b32 s18, s18, 4
    s_sub_u32 s18, s18, s17
    s_lshl_b32 s56, s17, 7
    s_sub_u32 s6, 1280000, s56
    s_mov_b32 s7, 0x20000
    s_mov_b32 m0, 131840
    v_lshrrev_b32 v4, 3, v3
    v_and_b32 v7, 7, v3
    v_xor_b32 v17, v7, v4
    v_lshlrev_b32 v17, 4, v17
    v_lshl_add_u32 v17, v4, 7, v17
    s_mul_i32 s58, s19, 1920
    v_lshl_add_u32 v16, v3, 7, s58
    v_min_u32 v16, 59996, v16
    v_mov_b32 v18, 0
    s_mov_b32 s57, 0
    s_cmp_ge_u32 s2, 16
    s_cbranch_scc1 L_whd
    v_lshrrev_b32 v18, 1, v3
    s_and_b32 s57, s2, 1
    s_lshl_b32 s57, s57, 12
    s_bitcmp1_b32 s2, 1
    s_cbranch_scc0 L_nperm
    v_and_b32 v19, 1, v18
    v_lshrrev_b32 v18, 1, v18
    v_lshl_add_u32 v18, v19, 5, v18
    s_lshr_b32 s57, s57, 1
    s_add_u32 s57, s57, 8192
L_nperm:
    v_lshlrev_b32 v18, 7, v18
    v_and_or_b32 v18, v2, 16, v18
    s_lshr_b32 s58, s2, 2
    s_lshl_b32 s58, s58, 5
    s_add_u32 s57, s57, s58
L_whd:
    s_waitcnt lgkmcnt(0)
    s_load_dword s39, s[14:15], s39
    s_add_u32 s4, s40, s56
    s_addc_u32 s5, s41, 0
    s_and_b32 s5, s5, 0xffff
    s_add_u32 s60, s50, 8192
    s_addc_u32 s61, s51, 0
    buffer_load_dwordx4 v17, s[4:7], 0 offen offset:0 nt lds
    buffer_load_dwordx4 v17, s[4:7], 0 offen offset:1024 nt lds
    buffer_load_dwordx4 v17, s[4:7], 0 offen offset:2048 nt lds
    buffer_load_dwordx4 v17, s[4:7], 0 offen offset:3072 nt lds
    s_mov_b32 m0, 135936
    s_movk_i32 s65, 0x1000
    buffer_load_dwordx4 v17, s[4:7], s65 offen nt lds
    s_mov_b32 m0, 25088
    s_nop 0
    global_load_lds_dwordx4 v2, s[60:61] offset:0
    global_load_lds_dwordx4 v2, s[60:61] offset:1024
    global_load_lds_dwordx4 v2, s[60:61] offset:2048
    global_load_lds_dwordx4 v2, s[60:61] offset:3072
    s_add_u32 s60, s60, 4096
    s_addc_u32 s61, s61, 0
    s_mov_b32 m0, 29184
    s_nop 0
    global_load_lds_dwordx4 v2, s[60:61] offset:0
    global_load_lds_dwordx4 v2, s[60:61] offset:1024
    global_load_lds_dwordx4 v2, s[60:61] offset:2048
    global_load_lds_dwordx4 v2, s[60:61] offset:3072
    s_cmp_ge_u32 s2, 16
    s_cbranch_scc1 L_nwh
    s_add_u32 s60, s54, s57
    s_addc_u32 s61, s55, 0
    s_mov_b32 m0, 33280
    s_nop 0
    global_load_lds_dwordx4 v18, s[60:61]
L_nwh:
    s_mov_b64 exec, 0x7fff
    global_load_dword v124, v16, s[42:43]
    s_mov_b64 exec, -1
    s_barrier
    s_setprio 3
    v_lshrrev_b32 v4, 5, v3
    v_and_b32 v6, 31, v3
    v_xor_b32 v7, v7, v4
    v_lshlrev_b32 v7, 4, v7
    v_lshl_add_u32 v7, v6, 7, v7
    v_add_u32 v8, 131840, v7
    v_xor_b32 v9, 32, v8
    v_xor_b32 v10, 64, v8
    v_xor_b32 v11, 96, v8
    v_bfe_u32 v5, v3, 2, 2
    v_lshl_add_u32 v5, v4, 3, v5
    v_and_b32 v13, 3, v3
    v_lshlrev_b32 v13, 3, v13
    v_and_b32 v14, 16, v3
    v_lshl_add_u32 v14, v14, 1, v13
    v_lshl_add_u32 v5, v5, 7, v14
    s_add_u32 s28, s14, s56
    s_addc_u32 s29, s15, 0
    s_and_b32 s29, s29, 0xffff
    s_lshl_b32 s30, s18, 7
    s_mov_b32 s31, 0x20000
    v_mov_b64 v[120:121], 0
    v_mov_b64 v[122:123], 0
    buffer_store_dwordx4 v[120:123], v2, s[28:31], 0 offen offset:3072 sc1
    buffer_store_dwordx4 v[120:123], v2, s[28:31], s65 offen offset:0 sc1
    s_waitcnt vmcnt(3) lgkmcnt(0)
    ds_read_b128 v[12:15], v8
    ds_read_b64_tr_b16 v[28:29], v5 offset:25088
    ds_read_b64_tr_b16 v[30:31], v5 offset:25600
    ds_read_b64_tr_b16 v[32:33], v5 offset:25152
    ds_read_b64_tr_b16 v[34:35], v5 offset:25664
    ds_read_b128 v[16:19], v9
    ds_read_b64_tr_b16 v[36:37], v5 offset:27136
    ds_read_b64_tr_b16 v[38:39], v5 offset:27648
    ds_read_b64_tr_b16 v[40:41], v5 offset:27200
    ds_read_b64_tr_b16 v[42:43], v5 offset:27712
    ds_read_b128 v[20:23], v10
    ds_read_b64_tr_b16 v[44:45], v5 offset:29184
    ds_read_b64_tr_b16 v[46:47], v5 offset:29696
    ds_read_b64_tr_b16 v[48:49], v5 offset:29248
    ds_read_b64_tr_b16 v[50:51], v5 offset:29760
    ds_read_b128 v[24:27], v11
    ds_read_b64_tr_b16 v[52:53], v5 offset:31232
    ds_read_b64_tr_b16 v[54:55], v5 offset:31744
    ds_read_b64_tr_b16 v[56:57], v5 offset:31296
    ds_read_b64_tr_b16 v[58:59], v5 offset:31808
    s_mov_b64 exec, 1
    ds_add_u32 v127, v127 offset:1812
    s_mov_b64 exec, -1
    s_waitcnt lgkmcnt(15)
    v_mfma_f32_32x32x16_bf16 v[60:75], v[12:15], v[28:31], 0
    s_mov_b32 s24, s14
    s_and_b32 s25, s15, 0xffff
    s_mov_b32 s8, s42
    s_and_b32 s9, s43, 0xffff
    s_mov_b32 s20, s14
    s_or_b32 s21, s25, 0x80000000
    v_mfma_f32_32x32x16_bf16 v[76:91], v[12:15], v[32:35], 0
    ds_read_b128 v[12:15], v8 offset:4096
    s_waitcnt lgkmcnt(14)
    v_mfma_f32_32x32x16_bf16 v[60:75], v[16:19], v[36:39], v[60:75]
    s_mov_b32 s26, 7147520
    s_mov_b32 s27, 0x20000
    s_add_u32 s28, s14, s56
    s_addc_u32 s29, s15, 0
    s_and_b32 s29, s29, 0xffff
    s_lshl_b32 s30, s18, 7
    s_waitcnt lgkmcnt(12)
    v_mfma_f32_32x32x16_bf16 v[76:91], v[16:19], v[40:43], v[76:91]
    ds_read_b128 v[16:19], v9 offset:4096
    s_waitcnt lgkmcnt(10)
    v_mfma_f32_32x32x16_bf16 v[60:75], v[20:23], v[44:47], v[60:75]
    s_mov_b32 s31, 0x20000
    s_mov_b32 s63, 0x1b800000
    v_lshlrev_b32 v7, 2, v6
    v_lshl_add_u32 v7, v4, 9, v7
    s_waitcnt lgkmcnt(8)
    v_mfma_f32_32x32x16_bf16 v[76:91], v[20:23], v[48:51], v[76:91]
    ds_read_b128 v[20:23], v10 offset:4096
    s_waitcnt lgkmcnt(6)
    v_mfma_f32_32x32x16_bf16 v[60:75], v[24:27], v[52:55], v[60:75]
    s_mul_i32 s39, s39, 0x9e3779b1
    s_add_u32 s39, s39, 0x7f4a7c15
    s_and_b32 s70, s39, 0xfc0f
    s_bfe_u32 s71, s39, 0x20004
    s_and_b32 s56, s39, 0xffff0000
    s_or_b32 s71, s71, s56
    s_waitcnt lgkmcnt(4)
    v_mfma_f32_32x32x16_bf16 v[76:91], v[24:27], v[56:59], v[76:91]
    ds_read_b128 v[24:27], v11 offset:4096
    v_lshrrev_b32 v1, 4, v3
    v_bfe_u32 v5, v3, 2, 2
    v_lshl_add_u32 v1, v1, 3, v5
    v_and_b32 v5, 3, v3
    v_lshlrev_b32 v5, 3, v5
    v_lshl_add_u32 v1, v1, 5, v5
    v_mul_f32 v60, s63, v60
    v_mul_f32 v61, s63, v61
    v_mul_f32 v62, s63, v62
    v_mul_f32 v63, s63, v63
    s_nop 0
    v_mul_f32 v76, s62, v76
    v_mul_f32 v77, s62, v77
    v_mul_f32 v78, s62, v78
    v_mul_f32 v79, s62, v79
    v_cvt_pk_bf16_f32 v60, v60, v76
    v_cvt_pk_bf16_f32 v61, v61, v77
    v_cvt_pk_bf16_f32 v62, v62, v78
    v_cvt_pk_bf16_f32 v63, v63, v79
    s_waitcnt lgkmcnt(3)
    v_mfma_f32_32x32x16_bf16 v[92:107], v[12:15], v[28:31], 0
    buffer_store_dword v60, v7, s[28:31], 0 offen offset:0 sc1
    buffer_store_dword v61, v7, s[28:31], 0 offen offset:128 sc1
    buffer_store_dword v62, v7, s[28:31], 0 offen offset:256 sc1
    buffer_store_dword v63, v7, s[28:31], 0 offen offset:384 sc1
    v_mul_f32 v64, s63, v64
    v_mul_f32 v65, s63, v65
    v_mul_f32 v66, s63, v66
    v_mul_f32 v67, s63, v67
    v_mfma_f32_32x32x16_bf16 v[108:123], v[12:15], v[32:35], 0
    v_mul_f32 v80, s62, v80
    v_mul_f32 v81, s62, v81
    v_mul_f32 v82, s62, v82
    v_mul_f32 v83, s62, v83
    s_waitcnt lgkmcnt(2)
    v_mfma_f32_32x32x16_bf16 v[92:107], v[16:19], v[36:39], v[92:107]
    v_cvt_pk_bf16_f32 v64, v64, v80
    v_cvt_pk_bf16_f32 v65, v65, v81
    v_cvt_pk_bf16_f32 v66, v66, v82
    v_cvt_pk_bf16_f32 v67, v67, v83
    v_mfma_f32_32x32x16_bf16 v[108:123], v[16:19], v[40:43], v[108:123]
    buffer_store_dword v64, v7, s[28:31], 0 offen offset:1024 sc1
    buffer_store_dword v65, v7, s[28:31], 0 offen offset:1152 sc1
    buffer_store_dword v66, v7, s[28:31], 0 offen offset:1280 sc1
    buffer_store_dword v67, v7, s[28:31], 0 offen offset:1408 sc1
    v_mul_f32 v68, s63, v68
    v_mul_f32 v69, s63, v69
    v_mul_f32 v70, s63, v70
    v_mul_f32 v71, s63, v71
    s_waitcnt lgkmcnt(1)
    v_mfma_f32_32x32x16_bf16 v[92:107], v[20:23], v[44:47], v[92:107]
    v_mul_f32 v84, s62, v84
    v_mul_f32 v85, s62, v85
    v_mul_f32 v86, s62, v86
    v_mul_f32 v87, s62, v87
    v_mfma_f32_32x32x16_bf16 v[108:123], v[20:23], v[48:51], v[108:123]
    v_cvt_pk_bf16_f32 v68, v68, v84
    v_cvt_pk_bf16_f32 v69, v69, v85
    v_cvt_pk_bf16_f32 v70, v70, v86
    v_cvt_pk_bf16_f32 v71, v71, v87
    s_waitcnt lgkmcnt(0)
    v_mfma_f32_32x32x16_bf16 v[92:107], v[24:27], v[52:55], v[92:107]
    buffer_store_dword v68, v7, s[28:31], 0 offen offset:2048 sc1
    buffer_store_dword v69, v7, s[28:31], 0 offen offset:2176 sc1
    buffer_store_dword v70, v7, s[28:31], 0 offen offset:2304 sc1
    buffer_store_dword v71, v7, s[28:31], 0 offen offset:2432 sc1
    v_mul_f32 v72, s63, v72
    v_mul_f32 v73, s63, v73
    v_mul_f32 v74, s63, v74
    v_mul_f32 v75, s63, v75
    v_mfma_f32_32x32x16_bf16 v[108:123], v[24:27], v[56:59], v[108:123]
    v_mul_f32 v88, s62, v88
    v_mul_f32 v89, s62, v89
    v_mul_f32 v90, s62, v90
    v_mul_f32 v91, s62, v91
    v_cvt_pk_bf16_f32 v72, v72, v88
    v_cvt_pk_bf16_f32 v73, v73, v89
    v_cvt_pk_bf16_f32 v74, v74, v90
    v_cvt_pk_bf16_f32 v75, v75, v91
    buffer_store_dword v72, v7, s[28:31], 0 offen offset:3072 sc1
    buffer_store_dword v73, v7, s[28:31], 0 offen offset:3200 sc1
    buffer_store_dword v74, v7, s[28:31], 0 offen offset:3328 sc1
    buffer_store_dword v75, v7, s[28:31], 0 offen offset:3456 sc1
    v_mul_f32 v92, s63, v92
    v_mul_f32 v93, s63, v93
    v_mul_f32 v94, s63, v94
    v_mul_f32 v95, s63, v95
    v_mul_f32 v108, s62, v108
    v_mul_f32 v109, s62, v109
    v_mul_f32 v110, s62, v110
    v_mul_f32 v111, s62, v111
    v_cvt_pk_bf16_f32 v92, v92, v108
    v_cvt_pk_bf16_f32 v93, v93, v109
    v_cvt_pk_bf16_f32 v94, v94, v110
    v_cvt_pk_bf16_f32 v95, v95, v111
    ds_write_b32 v7, v92 offset:38400
    ds_write_b32 v7, v93 offset:38528
    ds_write_b32 v7, v94 offset:38656
    ds_write_b32 v7, v95 offset:38784
    ds_read_b128 v[92:95], v2 offset:38400
    ds_read_b64_tr_b16 v[12:13], v1 offset:33280
    ds_read_b64_tr_b16 v[14:15], v1 offset:33408
    v_mov_b32 v8, 256
    s_mov_b64 exec, 1
    ds_add_u32 v127, v8 offset:1804
    s_mov_b64 exec, -1
    s_waitcnt lgkmcnt(3)
    buffer_store_dwordx4 v[92:95], v2, s[28:31], s65 offen offset:0 sc1
    s_cmp_ge_u32 s2, 16
    s_cbranch_scc1 L_g0
    s_lshl_b32 s57, s2, 10
    s_add_u32 s57, s57, 1310720
    s_waitcnt lgkmcnt(1)
    buffer_store_dwordx4 v[12:15], v2, s[24:27], s57 offen sc1
    s_branch L_g0
L_g0:
    s_waitcnt lgkmcnt(0)
    s_branch L_x
L_pos1:
    s_mul_i32 s64, s64, 20480
    s_add_u32 s64, s64, 2368
    s_setprio 1
    v_add_u32 v96, 0x4000000, v92
    v_add_u32 v97, 0x4010000, v92
    v_add_u32 v98, 0x4020000, v92
    v_add_u32 v99, 0x4030000, v92
    v_pk_mul_f32 v[96:97], v[96:97], s[62:63] op_sel_hi:[1,0]
    v_pk_mul_f32 v[98:99], v[98:99], s[62:63] op_sel_hi:[1,0]
    v_exp_f32 v100, -v96
    v_exp_f32 v101, -v97
    v_exp_f32 v102, -v98
    v_exp_f32 v103, -v99
    v_pk_add_f32 v[104:105], v[100:101], 1.0 op_sel_hi:[1,0]
    v_pk_add_f32 v[106:107], v[102:103], 1.0 op_sel_hi:[1,0]
    v_rcp_f32 v104, v104
    v_rcp_f32 v105, v105
    v_rcp_f32 v106, v106
    v_rcp_f32 v107, v107
    v_pk_mul_f32 v[96:97], v[96:97], v[104:105]
    v_pk_mul_f32 v[98:99], v[98:99], v[106:107]
    v_pk_mul_f32 v[100:101], v[96:97], v[100:101] neg_lo:[1,0] neg_hi:[1,0]
    v_pk_mul_f32 v[102:103], v[98:99], v[102:103] neg_lo:[1,0] neg_hi:[1,0]
    v_cvt_pk_bf16_f32 v96, v96, v97
    v_cvt_pk_bf16_f32 v97, v98, v99
    v_cvt_pk_bf16_f32 v100, v100, v101
    v_cvt_pk_bf16_f32 v101, v102, v103
    ds_write_b64 v93, v[96:97] offset:2048
    ds_write_b64 v94, v[100:101] offset:2048
    v_add_u32 v96, 0x8000000, v92
    v_add_u32 v97, 0x8010000, v92
    v_add_u32 v98, 0x8020000, v92
    v_add_u32 v99, 0x8030000, v92
    v_pk_mul_f32 v[96:97], v[96:97], s[62:63] op_sel_hi:[1,0]
    v_pk_mul_f32 v[98:99], v[98:99], s[62:63] op_sel_hi:[1,0]
    v_exp_f32 v100, -v96
    v_exp_f32 v101, -v97
    v_exp_f32 v102, -v98
    v_exp_f32 v103, -v99
    v_pk_add_f32 v[104:105], v[100:101], 1.0 op_sel_hi:[1,0]
    v_pk_add_f32 v[106:107], v[102:103], 1.0 op_sel_hi:[1,0]
    v_rcp_f32 v104, v104
    v_rcp_f32 v105, v105
    v_rcp_f32 v106, v106
    v_rcp_f32 v107, v107
    v_pk_mul_f32 v[96:97], v[96:97], v[104:105]
    v_pk_mul_f32 v[98:99], v[98:99], v[106:107]
    v_pk_mul_f32 v[100:101], v[96:97], v[100:101] neg_lo:[1,0] neg_hi:[1,0]
    v_pk_mul_f32 v[102:103], v[98:99], v[102:103] neg_lo:[1,0] neg_hi:[1,0]
    v_cvt_pk_bf16_f32 v96, v96, v97
    v_cvt_pk_bf16_f32 v97, v98, v99
    v_cvt_pk_bf16_f32 v100, v100, v101
    v_cvt_pk_bf16_f32 v101, v102, v103
    ds_write_b64 v93, v[96:97] offset:4096
    ds_write_b64 v94, v[100:101] offset:4096
    v_add_u32 v96, 0xc000000, v92
    v_add_u32 v97, 0xc010000, v92
    v_add_u32 v98, 0xc020000, v92
    v_add_u32 v99, 0xc030000, v92
    v_pk_mul_f32 v[96:97], v[96:97], s[62:63] op_sel_hi:[1,0]
    v_pk_mul_f32 v[98:99], v[98:99], s[62:63] op_sel_hi:[1,0]
    v_exp_f32 v100, -v96
    v_exp_f32 v101, -v97
    v_exp_f32 v102, -v98
    v_exp_f32 v103, -v99
    v_pk_add_f32 v[104:105], v[100:101], 1.0 op_sel_hi:[1,0]
    v_pk_add_f32 v[106:107], v[102:103], 1.0 op_sel_hi:[1,0]
    v_rcp_f32 v104, v104
    v_rcp_f32 v105, v105
    v_rcp_f32 v106, v106
    v_rcp_f32 v107, v107
    v_pk_mul_f32 v[96:97], v[96:97], v[104:105]
    v_pk_mul_f32 v[98:99], v[98:99], v[106:107]
    v_pk_mul_f32 v[100:101], v[96:97], v[100:101] neg_lo:[1,0] neg_hi:[1,0]
    v_pk_mul_f32 v[102:103], v[98:99], v[102:103] neg_lo:[1,0] neg_hi:[1,0]
    v_cvt_pk_bf16_f32 v96, v96, v97
    v_cvt_pk_bf16_f32 v97, v98, v99
    v_cvt_pk_bf16_f32 v100, v100, v101
    v_cvt_pk_bf16_f32 v101, v102, v103
    ds_write_b64 v93, v[96:97] offset:6144
    ds_write_b64 v94, v[100:101] offset:6144
    s_waitcnt lgkmcnt(0)
    s_mul_i32 s39, s39, 0x9e3779b1
    s_add_u32 s39, s39, 0x7f4a7c15
    s_and_b32 s70, s39, 0xfc0f
    s_bfe_u32 s71, s39, 0x20004
    s_and_b32 s56, s39, 0xffff0000
    s_or_b32 s71, s71, s56
    s_setprio 1
    v_add_u32 v4, s64, v2
    s_waitcnt vmcnt(20)
    s_cmp_eq_u32 s3, 13
    s_cbranch_scc1 L_k13
    s_cmp_eq_u32 s3, 14
    s_cbranch_scc1 L_k14
    s_cmp_eq_u32 s3, 15
    s_cbranch_scc0 L_kd
    v_and_b32 v96, 1, v3
    v_lshlrev_b32 v96, 4, v96
    v_mov_b32 v97, 0x3f80
    v_lshlrev_b32 v96, v96, v97
    v_bfe_u32 v97, v3, 1, 2
    v_cmp_eq_u32 vcc, 0, v97
    s_nop 1
    v_cndmask_b32 v92, 0, v96, vcc
    v_cmp_eq_u32 vcc, 1, v97
    s_nop 1
    v_cndmask_b32 v93, 0, v96, vcc
    v_cmp_eq_u32 vcc, 2, v97
    s_nop 1
    v_cndmask_b32 v94, 0, v96, vcc
    v_cmp_eq_u32 vcc, 3, v97
    s_nop 1
    v_cndmask_b32 v95, 0, v96, vcc
    v_lshlrev_b32 v97, 5, v3
    s_mov_b64 exec, 0xff
    ds_write_b128 v97, v[92:95] offset:0
    s_mov_b64 exec, -1
    v_mov_b64 v[92:93], 0
    v_mov_b64 v[94:95], 0
    v_add_u32 v97, 142080, v2
    ds_write_b128 v97, v[92:95]
    s_branch L_kd
L_k14:
    v_add_u32 v96, s17, v3
    v_and_b32 v96, 63, v96
    v_lshlrev_b32 v96, 3, v96
    v_lshl_or_b32 v108, v110, 16, v108
    ds_write_b64 v96, v[108:109] offset:1856
    s_branch L_kd
L_k13:
    v_cmp_gt_u32 vcc, 32, v3
    v_mov_b32 v92, s62
    v_mov_b32 v93, 0x1b800000
    v_cndmask_b32 v92, v92, v93, vcc
    s_mov_b32 s56, 143104
    v_lshl_add_u32 v97, v3, 1, s56
    v_lshl_add_u32 v96, v3, 2, s56
    v_lshlrev_b32 v108, 16, v108
    v_lshlrev_b32 v109, 16, v109
    v_lshlrev_b32 v110, 16, v110
    v_mul_f32 v93, v108, v92
    v_mul_f32 v94, v109, v92
    v_cvt_pk_bf16_f32 v94, v94, v93
    v_and_b32 v95, 0xffff0000, v94
    v_fma_f32 v93, v108, v92, -v95
    v_cvt_pk_bf16_f32 v93, v93, 0
    v_mul_f32 v95, 0x3f317218, v110
    ds_write_b16_d16_hi v97, v93
    ds_write_b16 v97, v94 offset:128
    ds_write_b16_d16_hi v97, v94 offset:256
    ds_write_b16 v97, v93 offset:384
    ds_write_b32 v96, v95 offset:512
L_kd:
    v_bfe_u32 v96, v0, 2, 5
    s_lshr_b32 s56, s3, 1
    v_lshl_add_u32 v97, v96, 3, s56
    v_lshlrev_b32 v113, 10, v97
    s_and_b32 s69, s16, 0xfc
    s_lshl_b32 s69, s69, 2
    s_add_u32 s69, s69, 1572864
    s_waitcnt vmcnt(16)
    v_lshrrev_b32 v15, 16, v14
    v_alignbit_b32 v14, v14, v13, 16
    v_and_b32 v13, 0xffff, v13
    v_lshrrev_b32 v19, 16, v18
    v_alignbit_b32 v18, v18, v17, 16
    v_and_b32 v17, 0xffff, v17
    v_lshrrev_b32 v23, 16, v22
    v_alignbit_b32 v22, v22, v21, 16
    v_and_b32 v21, 0xffff, v21
    v_lshrrev_b32 v27, 16, v26
    v_alignbit_b32 v26, v26, v25, 16
    v_and_b32 v25, 0xffff, v25
    s_waitcnt vmcnt(12)
    v_lshrrev_b32 v31, 16, v30
    v_alignbit_b32 v30, v30, v29, 16
    v_and_b32 v29, 0xffff, v29
    v_lshrrev_b32 v35, 16, v34
    v_alignbit_b32 v34, v34, v33, 16
    v_and_b32 v33, 0xffff, v33
    v_lshrrev_b32 v39, 16, v38
    v_alignbit_b32 v38, v38, v37, 16
    v_and_b32 v37, 0xffff, v37
    v_lshrrev_b32 v43, 16, v42
    v_alignbit_b32 v42, v42, v41, 16
    v_and_b32 v41, 0xffff, v41
    s_waitcnt vmcnt(8)
    v_lshrrev_b32 v47, 16, v46
    v_alignbit_b32 v46, v46, v45, 16
    v_and_b32 v45, 0xffff, v45
    v_lshrrev_b32 v51, 16, v50
    v_alignbit_b32 v50, v50, v49, 16
    v_and_b32 v49, 0xffff, v49
    v_lshrrev_b32 v55, 16, v54
    v_alignbit_b32 v54, v54, v53, 16
    v_and_b32 v53, 0xffff, v53
    v_lshrrev_b32 v59, 16, v58
    v_alignbit_b32 v58, v58, v57, 16
    v_and_b32 v57, 0xffff, v57
    s_waitcnt vmcnt(4)
    v_lshrrev_b32 v63, 16, v62
    v_alignbit_b32 v62, v62, v61, 16
    v_and_b32 v61, 0xffff, v61
    v_lshrrev_b32 v67, 16, v66
    v_alignbit_b32 v66, v66, v65, 16
    v_and_b32 v65, 0xffff, v65
    v_lshrrev_b32 v71, 16, v70
    v_alignbit_b32 v70, v70, v69, 16
    v_and_b32 v69, 0xffff, v69
    v_lshrrev_b32 v75, 16, v74
    v_alignbit_b32 v74, v74, v73, 16
    v_and_b32 v73, 0xffff, v73
L_sp3:
    ds_read_b32 v99, v127 offset:1804
    s_waitcnt lgkmcnt(0)
    v_cmp_ne_u32 vcc, 296, v99
    s_cbranch_vccnz L_sp3
    s_cmp_eq_u32 s3, 15
    ds_write_b128 v4, v[12:15] offset:0
    ds_write_b128 v4, v[16:19] offset:1024
    ds_write_b128 v4, v[20:23] offset:2048
    ds_write_b128 v4, v[24:27] offset:3072
    ds_write_b128 v4, v[28:31] offset:4096
    ds_write_b128 v4, v[32:35] offset:5120
    ds_write_b128 v4, v[36:39] offset:6144
    ds_write_b128 v4, v[40:43] offset:7168
    ds_write_b128 v4, v[44:47] offset:8192
    ds_write_b128 v4, v[48:51] offset:9216
    ds_write_b128 v4, v[52:55] offset:10240
    ds_write_b128 v4, v[56:59] offset:11264
    ds_write_b128 v4, v[60:63] offset:12288
    ds_write_b128 v4, v[64:67] offset:13312
    ds_write_b128 v4, v[68:71] offset:14336
    ds_write_b128 v4, v[72:75] offset:15360
    s_waitcnt vmcnt(3)
    v_lshrrev_b32 v79, 16, v78
    v_alignbit_b32 v78, v78, v77, 16
    v_and_b32 v77, 0xffff, v77
    s_waitcnt vmcnt(2)
    v_lshrrev_b32 v83, 16, v82
    v_alignbit_b32 v82, v82, v81, 16
    v_and_b32 v81, 0xffff, v81
    s_waitcnt vmcnt(1)
    v_lshrrev_b32 v87, 16, v86
    v_alignbit_b32 v86, v86, v85, 16
    v_and_b32 v85, 0xffff, v85
    s_waitcnt vmcnt(0)
    v_lshrrev_b32 v91, 16, v90
    v_alignbit_b32 v90, v90, v89, 16
    v_and_b32 v89, 0xffff, v89
    ds_write_b128 v4, v[76:79] offset:16384
    ds_write_b128 v4, v[80:83] offset:17408
    s_cselect_b64 exec, 0xff, -1
    ds_write_b128 v4, v[84:87] offset:18432
    s_cselect_b64 exec, 0, -1
    ds_write_b128 v4, v[88:91] offset:19456
    s_mov_b64 exec, 1
    ds_add_u32 v127, v127 offset:1808
    s_mov_b64 exec, -1
    buffer_load_dwordx4 v[108:111], v113, s[24:27], s69 offen sc1
    s_branch L_x1
.p2align 12
L_ic0:
    s_cbranch_execz L_icr
L_w4:
    s_setprio 0
L_sp8:
    ds_read_b32 v99, v127 offset:1820
    s_waitcnt lgkmcnt(0)
    v_cmp_ne_u32 vcc, 4, v99
    s_cbranch_vccnz L_sp8
    buffer_load_dwordx4 v[108:111], v113, s[24:27], s69 offen sc1
L_y1:
    v_and_b32 v44, 3, v3
    v_bfe_u32 v48, v0, 2, 5
    s_lshr_b32 s56, s3, 1
    v_lshrrev_b32 v118, 3, v113
    s_lshl_b32 s56, s56, 5
    v_add_u32 v48, s56, v48
    v_mul_u32_u24 v48, 625, v48
    v_add_u32 v48, 15, v48
    v_lshrrev_b32 v48, 4, v48
    v_lshl_add_u32 v49, v44, 5, s19
    v_add_lshl_u32 v116, v48, v49, 7
    v_cmp_gt_u32 s[32:33], 39, v49
    v_add_u32 v48, s17, v3
    v_and_b32 v48, 63, v48
    v_lshlrev_b32 v117, 2, v48
    v_lshrrev_b32 v45, 5, v3
    v_bfe_u32 v11, v3, 2, 2
    v_bfe_u32 v46, v3, 4, 1
    v_lshl_add_u32 v10, v46, 2, v44
    v_lshlrev_b32 v47, 3, v10
    v_lshlrev_b32 v48, 7, v45
    v_sub_u32 v125, 128, v48
    s_mov_b32 s56, 6144
    v_mad_u32_u24 v47, v45, s56, v47
    v_add_u32 v126, 136960, v47
    v_mad_u32_u24 v112, v11, v48, v126
    s_mov_b32 s56, 17600
    v_lshl_add_u32 v6, v45, 6, s56
    v_and_b32 v47, 1, v11
    v_bfe_u32 v48, v3, 3, 2
    v_lshl_add_u32 v49, v48, 2, v44
    v_lshl_add_u32 v49, v47, 4, v49
    v_lshlrev_b32 v46, 1, v45
    v_lshlrev_b32 v49, v46, v49
    v_lshlrev_b32 v0, v46, 64
    v_lshlrev_b32 v0, 1, v0
    v_lshl_add_u32 v49, v49, 2, s56
    s_mov_b32 s57, 12928
    v_mad_u32_u24 v7, v45, s57, v49
    v_lshrrev_b32 v48, 1, v11
    v_lshl_add_u32 v48, v47, 2, v48
    v_and_b32 v49, 2, v3
    v_add_u32 v49, v49, v44
    v_lshl_add_u32 v49, v49, 1, v48
    v_lshl_add_u32 v8, v49, 2, v6
    v_lshl_add_u32 v48, v45, 4, v48
    s_mov_b32 s56, 30528
    v_lshl_add_u32 v48, v48, 4, s56
    v_lshlrev_b32 v49, 29, v10
    v_sub_u32 v9, v48, v49
    s_mov_b32 s57, 1900544
    s_mov_b32 s58, 0xffc08007
    s_mov_b32 s59, 524288
    s_mov_b32 s60, 0x0000bf80
    s_mov_b32 s61, 0xbf800000
    s_mov_b32 s63, 2368
    s_mov_b32 s34, 0xfc0f
    s_mov_b32 s35, 0xffff0003
    s_mov_b32 s67, 1835008
    s_mov_b32 s37, 0
    s_branch L_chk
L_poll:
    s_sleep 2
    s_mov_b64 exec, vcc
    buffer_load_dwordx4 v[108:111], v113, s[24:27], s69 offen sc1
L_chk:
    s_waitcnt vmcnt(0)
    v_bitop3_b32 v104, v108, v109, s39 bitop3:0x7e
    v_bitop3_b32 v105, v110, v111, s39 bitop3:0x7e
    v_bitop3_b32 v104, v104, v105, s58 bitop3:0xa8
    v_cmp_ne_u32 vcc, 0, v104
    s_mov_b64 exec, -1
    s_cbranch_vccz L_got
    s_sub_u32 s59, s59, 1
    s_cmp_lg_u32 s59, 0
    s_cbranch_scc1 L_poll
    v_mov_b64 v[108:109], 0
    v_mov_b64 v[110:111], 0
L_got:
    s_bitcmp0_b32 s16, 1
    s_cbranch_scc1 L_g1
    v_mov_b64 v[108:109], v[110:111]
L_g1:
    s_bitcmp0_b32 s16, 0
    s_cbranch_scc1 L_g2
    v_mov_b32 v108, v109
L_g2:
    v_bfe_u32 v46, v108, 16, 6
    v_and_b32 v108, 0x7ff8, v108
    v_cmp_gt_u32 s[40:41], v46, v115
    v_add_u32 v114, v108, v114
    v_sub_u32 v47, v46, 8 clamp
    s_mov_b64 exec, s[40:41]
    buffer_load_dwordx4 v[76:79], v114, s[24:27], s57 offen sc1
    s_mov_b64 exec, -1
    v_mov_b32 v48, v47
    v_subrev_u32 v49, 1, v47
    v_ashrrev_i32 v49, 31, v49
    v_add_u32_dpp v48, v48, v48 row_shr:4 row_mask:0xf bank_mask:0xf
    v_add_u32 v50, 1, v115
    v_cmp_gt_u32 s[42:43], v46, v50
    v_add_u32_dpp v48, v48, v48 row_shr:8 row_mask:0xf bank_mask:0xf
    v_cmp_eq_u32 vcc, 63, v46
    v_mov_b64 v[12:13], 0
    v_add_u32_dpp v48, v48, v48 row_bcast:15 row_mask:0xa bank_mask:0xf
    v_mov_b64 v[14:15], 0
    v_mov_b64 v[16:17], 0
    v_add_u32_dpp v48, v48, v48 row_bcast:31 row_mask:0xc bank_mask:0xf
    v_sub_u32 v47, v48, v47
    v_readlane_b32 s56, v48, 63
    v_or_b32 v50, v47, v49
    v_min_u32 v50, 63, v50
    v_lshlrev_b32 v50, 2, v50
    v_add_lshl_u32 v51, v47, v115, 3
    v_sub_u32 v51, v114, v51
    ds_permute_b32 v44, v50, v51
    s_min_u32 s64, s56, 63
    s_bfm_b64 s[44:45], s64, 0
    s_mov_b64 s[46:47], 0
    s_cmp_gt_u32 s56, 126
    s_cselect_b64 exec, 1, vcc
    ds_write_b32 v127, v127 offset:1788
    s_mov_b64 exec, -1
    v_mov_b64 v[18:19], 0
    v_mov_b64 v[20:21], 0
    v_mov_b64 v[22:23], 0
    s_waitcnt lgkmcnt(1)
    v_max_u32_dpp v44, v44, v44 row_shr:1 row_mask:0xf bank_mask:0xf
    v_mov_b64 v[24:25], 0
    v_mov_b64 v[26:27], 0
    v_max_u32_dpp v44, v44, v44 row_shr:2 row_mask:0xf bank_mask:0xf
    v_mov_b64 v[28:29], 0
    v_mov_b64 v[30:31], 0
    v_max_u32_dpp v44, v44, v44 row_shr:4 row_mask:0xf bank_mask:0xf
    v_mov_b64 v[32:33], 0
    v_mov_b64 v[34:35], 0
    v_max_u32_dpp v44, v44, v44 row_shr:8 row_mask:0xf bank_mask:0xf
    v_mov_b64 v[36:37], 0
    v_mov_b64 v[38:39], 0
    v_max_u32_dpp v44, v44, v44 row_bcast:15 row_mask:0xa bank_mask:0xf
    v_mov_b64 v[40:41], 0
    v_mov_b64 v[42:43], 0
    v_max_u32_dpp v44, v44, v44 row_bcast:31 row_mask:0xc bank_mask:0xf
    v_lshl_add_u32 v44, v3, 3, v44
    s_cmp_gt_u32 s56, 63
    s_cbranch_scc1 L_t3
L_t3d:
    s_mov_b64 exec, s[44:45]
    buffer_load_dwordx2 v[80:81], v44, s[24:27], s57 offen offset:64 sc1
    s_mov_b64 exec, -1
    s_setprio 0
L_sp4:
    ds_read_b32 v109, v127 offset:1808
    s_waitcnt lgkmcnt(0)
    v_cmp_ne_u32 vcc, 16, v109
    s_cbranch_vccnz L_sp4
L_hw:
    s_waitcnt vmcnt(1)
    v_xor_b32 v86, s70, v76
    v_xor_b32 v104, s71, v77
    v_xor_b32 v90, s70, v78
    v_xor_b32 v105, s71, v79
    v_bitop3_b32 v108, v86, v90, s34 bitop3:0xa8
    v_bitop3_b32 v109, v104, v105, s35 bitop3:0xa8
    v_or_b32 v108, v108, v109
    v_cmp_ne_u32 vcc, 0, v108
    s_nop 0
    s_and_b64 vcc, vcc, s[40:41]
    s_cbranch_scc1 L_hr
    v_bfe_u32 v120, v86, 2, 8
    v_lshl_add_u32 v60, v104, 1, s63
    v_bfe_u32 v62, v86, 1, 9
    v_bfe_u32 v121, v90, 2, 8
    v_lshl_add_u32 v64, v105, 1, s63
    v_bfe_u32 v66, v90, 1, 9
L_ic1:
    s_cbranch_execz L_icr
    s_mov_b64 exec, s[40:41]
    ds_add_rtn_u32 v100, v120, v127 offset:1024
    ds_read_b64 v[60:61], v60
    ds_read_b64 v[62:63], v62 offset:1856
    s_mov_b64 exec, s[42:43]
    ds_add_rtn_u32 v101, v121, v127 offset:1024
    ds_read_b64 v[64:65], v64
    ds_read_b64 v[66:67], v66 offset:1856
    s_mov_b64 exec, -1
    v_lshl_or_b32 v104, v86, 25, v104
    v_lshl_or_b32 v105, v90, 25, v105
L_tw:
    s_waitcnt vmcnt(0)
    v_xor_b32 v94, s70, v80
    v_xor_b32 v106, s71, v81
    v_and_b32 v108, s34, v94
    v_and_or_b32 v108, v106, s35, v108
    v_cmp_ne_u32 vcc, 0, v108
    s_nop 0
    s_and_b64 vcc, vcc, s[44:45]
    s_cbranch_scc1 L_tr
    v_bfe_u32 v122, v94, 2, 8
    v_lshl_add_u32 v68, v106, 1, s63
    v_bfe_u32 v70, v94, 1, 9
    s_mov_b64 exec, s[44:45]
    ds_add_rtn_u32 v102, v122, v127 offset:1024
    ds_read_b64 v[68:69], v68
    ds_read_b64 v[70:71], v70 offset:1856
    s_mov_b64 exec, -1
    v_lshl_or_b32 v106, v94, 25, v106
    buffer_load_dwordx2 v[4:5], v118, s[24:27], s67 offen sc1
    s_cmp_lg_u64 s[46:47], 0
    s_cbranch_scc1 L_p3
L_p3d:
    s_waitcnt lgkmcnt(0)
    s_barrier
    ds_read_b32 v108, v117 offset:1024
    s_mov_b64 exec, s[32:33]
    buffer_load_dword v115, v116, s[24:27], 0 offen sc1
    s_mov_b64 exec, -1
    s_waitcnt lgkmcnt(0)
    v_mov_b32 v109, v108
    s_nop 1
    v_add_u32_dpp v109, v109, v109 row_shr:1 row_mask:0xf bank_mask:0xf
    s_nop 1
    v_add_u32_dpp v109, v109, v109 row_shr:2 row_mask:0xf bank_mask:0xf
    s_nop 1
    v_add_u32_dpp v109, v109, v109 row_shr:4 row_mask:0xf bank_mask:0xf
    s_nop 1
    v_add_u32_dpp v109, v109, v109 row_shr:8 row_mask:0xf bank_mask:0xf
    s_nop 1
    v_add_u32_dpp v109, v109, v109 row_bcast:15 row_mask:0xa bank_mask:0xf
    s_nop 1
    v_add_u32_dpp v109, v109, v109 row_bcast:31 row_mask:0xc bank_mask:0xf
    v_sub_u32 v108, v109, v108
    v_readlane_b32 s56, v109, 63
    ds_write_b32 v117, v108 offset:1280
    s_mov_b64 exec, s[40:41]
    ds_read_b32 v120, v120 offset:1280
    s_mov_b64 exec, s[42:43]
    ds_read_b32 v121, v121 offset:1280
    s_mov_b64 exec, s[44:45]
    ds_read_b32 v122, v122 offset:1280
    s_mov_b64 exec, -1
    s_cmp_gt_u32 s56, 12800
    s_cbranch_scc1 L_big
    v_lshlrev_b32 v44, 16, v62
    v_and_b32 v45, 0xffff0000, v62
    v_lshlrev_b32 v63, 16, v63
    v_lshlrev_b32 v46, 16, v66
    v_and_b32 v47, 0xffff0000, v66
    v_lshlrev_b32 v67, 16, v67
    v_lshlrev_b32 v48, 16, v70
    v_and_b32 v49, 0xffff0000, v70
    v_lshlrev_b32 v71, 16, v71
    v_dot2_f32_bf16 v44, v60, s60, v44
    v_dot2_f32_bf16 v46, v64, s60, v46
    v_dot2_f32_bf16 v48, v68, s60, v48
    v_dot2_f32_bf16 v45, v60, s61, v45
    v_dot2_f32_bf16 v47, v64, s61, v47
    v_dot2_f32_bf16 v49, v68, s61, v49
    v_dot2_f32_bf16 v63, v61, s60, v63
    v_dot2_f32_bf16 v67, v65, s60, v67
    v_dot2_f32_bf16 v71, v69, s60, v71
    v_cvt_pk_bf16_f32 v84, 1.0, v44
    v_cvt_pk_bf16_f32 v88, 1.0, v46
    v_cvt_pk_bf16_f32 v92, 1.0, v48
    v_cvt_pk_bf16_f32 v85, v45, v63
    v_cvt_pk_bf16_f32 v89, v47, v67
    v_cvt_pk_bf16_f32 v93, v49, v71
    v_mul_f32 v60, v44, v44
    v_mul_f32 v64, v46, v46
    v_mul_f32 v68, v48, v48
    v_dot2_f32_bf16 v60, v85, v85, v60
    v_dot2_f32_bf16 v64, v89, v89, v64
    v_dot2_f32_bf16 v68, v93, v93, v68
    s_waitcnt lgkmcnt(0)
    v_add_u32 v100, v100, v120
    v_add_u32 v101, v101, v121
    v_add_u32 v102, v102, v122
    v_cvt_pk_bf16_f32 v87, v60, v60
    v_cvt_pk_bf16_f32 v91, v64, v64
    v_cvt_pk_bf16_f32 v95, v68, v68
    v_lshlrev_b32 v120, 2, v100
    v_lshlrev_b32 v121, 2, v101
    v_lshlrev_b32 v122, 2, v102
    s_mov_b64 exec, s[40:41]
    ds_write_b32 v100, v104 offset:17600
    ds_write_b128 v120, v[84:87] offset:30528
    s_mov_b64 exec, s[42:43]
    ds_write_b32 v101, v105 offset:17600
    ds_write_b128 v121, v[88:91] offset:30528
    s_mov_b64 exec, s[44:45]
    ds_write_b32 v102, v106 offset:17600
    ds_write_b128 v122, v[92:95] offset:30528
    s_mov_b64 exec, -1
    s_cmp_lg_u64 s[46:47], 0
    s_cbranch_scc1 L_v3
L_v3d:
    s_cmp_lg_u32 s3, 0
    s_cbranch_scc1 L_nopadrv
    v_lshl_add_u32 v110, v3, 2, s56
    v_lshlrev_b32 v111, 2, v110
    s_mov_b32 exec_hi, 0
    ds_write_b32 v110, v12 offset:17600
    ds_write_b128 v111, v[12:15] offset:30528
    s_mov_b32 exec_hi, -1
L_nopadrv:
L_f2:
    s_waitcnt vmcnt(1)
    v_xor_b32 v4, s39, v4
    v_xnor_b32 v5, s39, v5
    v_or_b32 v4, v4, v5
    v_cmp_ne_u32 vcc, 0, v4
    s_cbranch_vccnz L_f2retry
L_f2ok:
    s_add_u32 s57, s56, 124
    s_lshr_b32 s57, s57, 7
    s_lshr_b32 s58, s57, 4
    s_and_b32 s57, s57, 15
    s_mul_i32 s64, s58, s3
    s_min_u32 s63, s3, s57
    s_add_u32 s64, s64, s63
    s_cmp_lt_u32 s3, s57
    s_addc_u32 s38, s58, 0
    s_mov_b32 s37, s64
    s_lshl_b32 s64, s64, 7
    s_cmp_eq_u32 s38, 0
    s_cbranch_scc1 L_nowin
    s_lshl_b32 s65, s38, 7
    s_add_u32 s65, s65, s64
    s_min_u32 s65, s65, s56
    s_sub_u32 s65, s65, 4
    v_cmp_ge_u32 vcc, s64, v109
    v_add_u32 v6, s64, v6
    s_bcnt1_i32_b64 s66, vcc
    v_cmp_ge_u32 vcc, s65, v109
    s_lshl_b32 s58, s64, 2
    s_bcnt1_i32_b64 s67, vcc
    s_sub_u32 s67, s67, s66
    s_lshl_b32 s57, 1, s3
    v_add_lshl_u32 v110, s66, v3, 2
    v_mov_b32 v111, s57
    v_add_u32 v8, s64, v8
    s_lshl_b64 exec, 2, s67
    s_sub_u32 exec_lo, exec_lo, 1
    s_subb_u32 exec_hi, exec_hi, 0
    ds_or_b32 v110, v111 offset:1536
    s_cmp_gt_u32 s67, 6
    s_cselect_b64 exec, 1, 0
    ds_write_b32 v127, v127 offset:1788
    s_mov_b64 exec, -1
    s_add_u32 s63, s17, s66
    s_cmp_ge_u32 s3, 12
    s_cbranch_scc1 L_nowin
    v_subrev_u32 v110, s63, v11
    v_and_b32 v110, 7, v110
    v_xor_b32 v111, 4, v110
    v_add_u32 v110, s66, v110
    v_add_u32 v111, s66, v111
    v_mad_u32_u24 v110, v110, v125, v126
    v_mad_u32_u24 v111, v111, v125, v112
    v_add_u32 v9, s58, v9
    v_and_b32 v1, 31, v3
    v_lshlrev_b32 v1, 2, v1
    v_add_u32 v112, 143616, v1
    ds_read_b64_tr_b16 v[120:121], v110
L_ic2:
    s_cbranch_execz L_icr
    ds_read_b64_tr_b16 v[122:123], v111
    ds_read_b64_tr_b16 v[124:125], v110 offset:64
    ds_read_b64_tr_b16 v[126:127], v111 offset:64
    ds_read2_b32 v[10:11], v112 offset0:0 offset1:32
    v_lshrrev_b32 v112, 5, v3
    s_movk_i32 s57, 272
    v_mad_u32_u24 v1, v112, s57, v1
L_nowin:
    v_mad_u32_u24 v5, s37, v0, v7
    v_mov_b32 v113, 0
    s_waitcnt lgkmcnt(0)
    s_barrier
    ds_read_b32 v113, v113 offset:1792
    ds_read_b128 v[44:47], v6 offset:0
    ds_read_b128 v[48:51], v6 offset:16
    ds_read_b128 v[52:55], v6 offset:32
    ds_read_b128 v[56:59], v6 offset:48
    s_mov_b32 exec_hi, 0
    ds_read_u8 v5, v5 offset:3
    s_mov_b32 exec_hi, -1
    s_add_u32 s37, s37, 1
    ds_read_u16_d16_hi v4, v8 offset:2
    s_waitcnt lgkmcnt(6)
    v_cmp_ne_u32 vcc, 0, v113
    s_cbranch_vccnz L_slow
    s_cmp_eq_u32 s38, 0
    s_cbranch_scc1 L_prep
    s_setprio 3
    s_waitcnt lgkmcnt(5)
    buffer_load_dword v44, v44, s[20:23], 0 offen sc1
    buffer_load_dword v45, v45, s[20:23], 0 offen sc1
    buffer_load_dword v46, v46, s[20:23], 0 offen sc1
    buffer_load_dword v47, v47, s[20:23], 0 offen sc1
    s_waitcnt lgkmcnt(4)
    buffer_load_dword v48, v48, s[20:23], 0 offen sc1
    buffer_load_dword v49, v49, s[20:23], 0 offen sc1
    buffer_load_dword v50, v50, s[20:23], 0 offen sc1
    buffer_load_dword v51, v51, s[20:23], 0 offen sc1
    s_waitcnt lgkmcnt(3)
    buffer_load_dword v52, v52, s[20:23], 0 offen sc1
    buffer_load_dword v53, v53, s[20:23], 0 offen sc1
    buffer_load_dword v54, v54, s[20:23], 0 offen sc1
    buffer_load_dword v55, v55, s[20:23], 0 offen sc1
    s_waitcnt lgkmcnt(2)
    buffer_load_dword v56, v56, s[20:23], 0 offen sc1
    buffer_load_dword v57, v57, s[20:23], 0 offen sc1
    buffer_load_dword v58, v58, s[20:23], 0 offen sc1
    buffer_load_dword v59, v59, s[20:23], 0 offen sc1
    s_waitcnt lgkmcnt(1)
    ds_read_b128 v[116:119], v5
    s_cmp_lt_u32 s3, 12
    s_cbranch_scc1 L_prep
    v_subrev_u32 v110, s63, v11
    v_and_b32 v110, 7, v110
    v_xor_b32 v111, 4, v110
    v_add_u32 v110, s66, v110
    v_add_u32 v111, s66, v111
    v_mad_u32_u24 v110, v110, v125, v126
    v_mad_u32_u24 v111, v111, v125, v112
    v_add_u32 v9, s58, v9
    v_and_b32 v1, 31, v3
    v_lshlrev_b32 v1, 2, v1
    v_add_u32 v112, 143616, v1
    ds_read_b64_tr_b16 v[120:121], v110
    ds_read_b64_tr_b16 v[122:123], v111
    ds_read_b64_tr_b16 v[124:125], v110 offset:64
    ds_read_b64_tr_b16 v[126:127], v111 offset:64
    ds_read2_b32 v[10:11], v112 offset0:0 offset1:32
    v_lshrrev_b32 v112, 5, v3
    s_movk_i32 s57, 272
    v_mad_u32_u24 v1, v112, s57, v1
L_prep:
    ds_read_b128 v[60:63], v6 offset:128
    ds_read_b128 v[64:67], v6 offset:144
    ds_read_b128 v[68:71], v6 offset:160
    ds_read_b128 v[72:75], v6 offset:176
    s_cmp_ge_u32 s3, 12
    s_cbranch_scc1 L_prp
    s_lshr_b32 s58, s3, 2
    s_lshl_b32 s58, s58, 4
    v_and_or_b32 v76, v3, 15, s58
    v_lshlrev_b32 v80, 2, v76
    ds_read_b32 v80, v80 offset:1536
    s_movk_i32 s59, 0x70
    v_bitop3_b32 v78, v3, v2, s59 bitop3:0x28
    v_lshl_add_u32 v78, v76, 7, v78
    v_add_u32 v104, 131840, v78
    v_and_b32 v77, 48, v3
    v_and_b32 v79, 15, v3
    s_and_b32 s57, s3, 3
    s_lshl_b32 s57, s57, 5
    s_lshl_b32 s58, s58, 7
    s_add_u32 s57, s57, s58
    v_lshl_add_u32 v79, v79, 1, s57
    v_lshl_add_u32 v105, v77, 5, v79
    v_lshlrev_b32 v88, 2, v3
    v_bitop3_b32 v88, v105, v88, 64 bitop3:0x78
    v_add_u32 v88, 131840, v88
    v_xor_b32 v89, 16, v88
    v_xor_b32 v90, 32, v88
    v_xor_b32 v91, 48, v88
    ds_read_u16_d16_hi v100, v88
    ds_read_u16_d16_hi v101, v89 offset:128
    ds_read_u16_d16_hi v102, v90 offset:256
    ds_read_u16_d16_hi v103, v91 offset:384
    s_lshl_b32 s59, s17, 7
    s_add_u32 s32, s12, s59
    s_addc_u32 s33, s13, 0
    s_lshl_b32 s34, s18, 7
    s_branch L_prq
L_prp:
    s_sub_u32 s58, s3, 12
    s_lshl_b32 s58, s58, 6
    v_and_or_b32 v78, v3, 60, s58
    ds_read_b32 v80, v78 offset:1536
    v_lshrrev_b32 v76, 2, v78
    v_bfrev_b32 v77, v3
    v_lshrrev_b32 v77, 26, v77
    v_and_b32 v77, 48, v77
    v_and_b32 v78, 3, v3
L_ic3:
    s_cbranch_execz L_icr
    v_add_u32 v79, s17, v76
    v_and_b32 v85, 63, v79
    v_lshlrev_b32 v85, 3, v85
    v_lshl_add_u32 v85, v78, 1, v85
    ds_read_u16_d16_hi v100, v85 offset:1856
    v_mul_u32_u24 v79, 6, v79
    v_lshl_add_u32 v105, v78, 1, v79
    v_cmp_gt_u32 vcc, s18, v76
    s_nop 0
    s_and_b32 s54, vcc_lo, 0x77777777
    s_and_b32 s55, vcc_hi, 0x77777777
    s_add_u32 s32, s12, 1280000
    s_addc_u32 s33, s13, 0
    s_mov_b32 s34, 60000
L_prq:
    s_and_b32 s33, s33, 0xffff
    s_mov_b32 s35, 0x20000
    s_mov_b32 s60, 0x3f317218
    s_waitcnt lgkmcnt(0)
    v_ffbl_b32 v83, v80
    v_bcnt_u32_b32 v80, v80, -2
    v_add_u32 v83, v83, v76
    s_movk_i32 s58, 272
    s_brev_b32 s59, 2
    v_mad_u32_u24 v83, v83, s58, v77
    v_add_u32 v81, 1, v80
    v_and_or_b32 v107, v80, s59, v83
    v_and_or_b32 v106, v81, s59, v83
    v_cmp_lt_i32 s[52:53], 0, v80
    s_cmp_eq_u32 s38, 0
    s_cbranch_scc1 L_tail
    s_setprio 3
    s_branch L_mloop
L_t3:
    v_subrev_u32 v50, 64, v48
    v_ashrrev_i32 v50, 31, v50
    v_sub_u32 v52, v47, 63 clamp
    v_or3_b32 v50, v50, v49, v52
    v_min_u32 v50, 63, v50
    v_lshlrev_b32 v50, 2, v50
    ds_permute_b32 v45, v50, v51
    s_sub_u32 s64, s56, 63
    s_min_u32 s64, s64, 63
    s_bfm_b64 s[46:47], s64, 0
    s_waitcnt lgkmcnt(0)
    v_max_u32_dpp v45, v45, v45 row_shr:1 row_mask:0xf bank_mask:0xf
    s_nop 1
    v_max_u32_dpp v45, v45, v45 row_shr:2 row_mask:0xf bank_mask:0xf
    s_nop 1
    v_max_u32_dpp v45, v45, v45 row_shr:4 row_mask:0xf bank_mask:0xf
    s_nop 1
    v_max_u32_dpp v45, v45, v45 row_shr:8 row_mask:0xf bank_mask:0xf
    s_nop 1
    v_max_u32_dpp v45, v45, v45 row_bcast:15 row_mask:0xa bank_mask:0xf
    s_nop 1
    v_max_u32_dpp v45, v45, v45 row_bcast:31 row_mask:0xc bank_mask:0xf
    v_lshl_add_u32 v45, v3, 3, v45
    s_mov_b64 exec, s[46:47]
    buffer_load_dwordx2 v[82:83], v45, s[24:27], s57 offen offset:568 sc1
    s_mov_b64 exec, -1
    s_branch L_t3d
L_p3:
    v_xor_b32 v98, s70, v82
    v_xor_b32 v107, s71, v83
    v_and_b32 v108, s34, v98
    v_and_or_b32 v108, v107, s35, v108
    v_cmp_ne_u32 vcc, 0, v108
    s_nop 0
    s_and_b64 vcc, vcc, s[46:47]
    s_cbranch_scc1 L_3r
    v_bfe_u32 v123, v98, 2, 8
    v_lshl_add_u32 v72, v107, 1, s63
    v_bfe_u32 v74, v98, 1, 9
    s_mov_b64 exec, s[46:47]
    ds_add_rtn_u32 v103, v123, v127 offset:1024
    ds_read_b64 v[72:73], v72
    ds_read_b64 v[74:75], v74 offset:1856
    s_mov_b64 exec, -1
    v_lshl_or_b32 v107, v98, 25, v107
    s_waitcnt lgkmcnt(0)
    s_branch L_p3d
L_v3:
    s_mov_b64 exec, s[46:47]
    ds_read_b32 v123, v123 offset:1280
    s_mov_b64 exec, -1
    v_lshlrev_b32 v44, 16, v74
    v_and_b32 v45, 0xffff0000, v74
    v_lshlrev_b32 v75, 16, v75
    v_dot2_f32_bf16 v44, v72, s60, v44
    v_dot2_f32_bf16 v45, v72, s61, v45
    v_dot2_f32_bf16 v75, v73, s60, v75
    s_nop 0
    v_cvt_pk_bf16_f32 v96, 1.0, v44
    s_nop 0
    v_cvt_pk_bf16_f32 v97, v45, v75
    v_mul_f32 v72, v44, v44
    v_dot2_f32_bf16 v72, v97, v97, v72
    s_waitcnt lgkmcnt(0)
    v_add_u32 v103, v103, v123
    s_nop 0
    v_cvt_pk_bf16_f32 v99, v72, v72
    v_lshlrev_b32 v123, 2, v103
    s_mov_b64 exec, s[46:47]
    ds_write_b32 v103, v107 offset:17600
    ds_write_b128 v123, v[96:99] offset:30528
    s_mov_b64 exec, -1
    s_nop 1
    s_branch L_v3d
L_hr:
    s_sleep 4
    s_sub_u32 s59, s59, 1
    s_cmp_gt_i32 s59, 0
    s_cbranch_scc1 L_hr1
    s_mov_b64 s[40:41], 0
    s_mov_b64 s[42:43], 0
    s_branch L_hw
L_hr1:
    s_mov_b64 exec, s[40:41]
    buffer_load_dwordx4 v[76:79], v114, s[24:27], s57 offen sc1
    s_mov_b64 exec, -1
    s_waitcnt vmcnt(0)
    s_branch L_hw
L_tr:
    s_sleep 4
    s_sub_u32 s59, s59, 1
    s_cmp_gt_i32 s59, 0
    s_cbranch_scc1 L_tr1
    s_mov_b64 s[44:45], 0
    s_branch L_tw
L_tr1:
    s_mov_b64 exec, s[44:45]
    buffer_load_dwordx2 v[80:81], v44, s[24:27], s57 offen offset:64 sc1
    s_mov_b64 exec, -1
    s_waitcnt vmcnt(0)
    s_branch L_tw
L_3r:
    s_sleep 4
    s_sub_u32 s59, s59, 1
    s_cmp_gt_i32 s59, 0
    s_cbranch_scc1 L_3r1
    s_mov_b64 s[46:47], 0
    s_branch L_p3
L_3r1:
    s_mov_b64 exec, s[46:47]
    buffer_load_dwordx2 v[82:83], v45, s[24:27], s57 offen offset:568 sc1
    s_mov_b64 exec, -1
    s_waitcnt vmcnt(0)
    s_branch L_p3
L_f2retry:
    s_sleep 4
    buffer_load_dwordx2 v[4:5], v118, s[24:27], s67 offen sc1
    s_waitcnt vmcnt(0)
    s_sub_u32 s59, s59, 1
    s_cmp_gt_i32 s59, 0
    s_cbranch_scc1 L_f2
    s_branch L_f2ok
L_big:
    s_waitcnt lgkmcnt(0)
    ds_write_b32 v127, v127 offset:1788
    s_mov_b32 s38, 0
L_bigf:
    s_waitcnt vmcnt(1)
    buffer_load_dwordx2 v[4:5], v118, s[24:27], s67 offen sc1
    s_waitcnt vmcnt(0)
    v_xor_b32 v4, s39, v4
    v_xnor_b32 v5, s39, v5
    v_or_b32 v4, v4, v5
    v_cmp_ne_u32 vcc, 0, v4
    s_cbranch_vccz L_nowin
    s_sleep 4
    s_sub_u32 s59, s59, 1
    s_cmp_gt_i32 s59, 0
    s_cbranch_scc1 L_bigf
    s_branch L_nowin
.p2align 12
L_ic4:
    s_cbranch_execz L_icr
L_mloop:
    s_cmp_gt_u32 s38, 3
    s_cbranch_scc1 L_go0
    s_setprio 2
    s_cmp_eq_u32 s38, 3
    s_cbranch_scc1 L_go0
    s_setprio 1
    s_cmp_eq_u32 s38, 1
    s_cbranch_scc1 L_last0
L_go0:
    s_waitcnt vmcnt(0)
    v_lshlrev_b64 v[80:81], 16, v[48:49]
    v_lshlrev_b64 v[82:83], 16, v[50:51]
    s_waitcnt lgkmcnt(2)
    buffer_load_dword v61, v61, s[20:23], 0 offen sc1
    v_add_u32_dpp v114, v4, v9 quad_perm:[3,3,3,3] row_mask:0xf bank_mask:0xf bound_ctrl:1
    v_mad_u32_u24 v5, s37, v0, v7
    v_lshlrev_b64 v[90:91], 16, v[58:59]
    v_lshlrev_b64 v[76:77], 16, v[44:45]
    v_lshlrev_b64 v[86:87], 16, v[54:55]
    v_lshlrev_b64 v[88:89], 16, v[56:57]
    v_lshlrev_b64 v[78:79], 16, v[46:47]
    v_lshlrev_b64 v[84:85], 16, v[52:53]
    s_mov_b32 exec_hi, 0
    ds_read_u8 v5, v5 offset:3
    s_mov_b32 exec_hi, -1
    s_add_u32 s37, s37, 1
    v_mfma_f32_32x32x16_bf16 v[76:91], v[116:119], v[120:123], v[76:91]
    v_add_u32_dpp v110, v4, v9 quad_perm:[1,1,1,1] row_mask:0xf bank_mask:0xf bound_ctrl:1
    v_add_u32_dpp v112, v4, v9 quad_perm:[2,2,2,2] row_mask:0xf bank_mask:0xf bound_ctrl:1
    v_add_u32_dpp v108, v4, v9 quad_perm:[0,0,0,0] row_mask:0xf bank_mask:0xf bound_ctrl:1
    ds_read_b64_tr_b16 v[114:115], v114 offset:160
    ds_read_b64_tr_b16 v[110:111], v110 offset:32
    buffer_load_dword v65, v65, s[20:23], 0 offen sc1
    ds_read_b64_tr_b16 v[108:109], v108 offset:0
    v_mfma_f32_32x32x16_bf16 v[44:59], v[116:119], v[124:127], v[44:59]
    s_nop 3
    v_mad_u32_u16 v78, v78, 2, s36 op_sel:[1,0,0,0]
    v_mad_u32_u16 v77, v77, 2, s36 op_sel:[1,0,0,0]
    v_mad_u32_u16 v89, v89, 2, s36 op_sel:[1,0,0,0]
    v_mad_u32_u16 v79, v79, 2, s36 op_sel:[1,0,0,0]
    ds_read_u16 v77, v77
    ds_read_u16 v78, v78
    s_nop 1
    v_exp_f32 v94, -v46
    v_exp_f32 v93, -v45
    v_mad_u32_u16 v76, v76, 2, s36 op_sel:[1,0,0,0]
    v_exp_f32 v97, -v49
    v_exp_f32 v98, -v50
    ds_read_b64_tr_b16 v[112:113], v112 offset:128
    ds_read_u16 v79, v79
    v_mad_u32_u16 v81, v81, 2, s36 op_sel:[1,0,0,0]
    v_exp_f32 v99, -v51
    v_mad_u32_u16 v82, v82, 2, s36 op_sel:[1,0,0,0]
    buffer_load_dword v63, v63, s[20:23], 0 offen sc1
    buffer_load_dword v60, v60, s[20:23], 0 offen sc1
    v_exp_f32 v95, -v47
    v_exp_f32 v92, -v44
    ds_read_u16 v76, v76
    s_waitcnt lgkmcnt(10)
    buffer_load_dword v73, v73, s[20:23], 0 offen sc1
    buffer_load_dword v67, v67, s[20:23], 0 offen sc1
    v_mad_u32_u16 v80, v80, 2, s36 op_sel:[1,0,0,0]
    v_exp_f32 v96, -v48
    buffer_load_dword v64, v64, s[20:23], 0 offen sc1
    v_pk_add_f32 v[94:95], v[94:95], 1.0 op_sel_hi:[1,0]
    v_pk_add_f32 v[98:99], v[98:99], 1.0 op_sel_hi:[1,0]
    v_pk_add_f32 v[92:93], v[92:93], 1.0 op_sel_hi:[1,0]
    v_pk_add_f32 v[96:97], v[96:97], 1.0 op_sel_hi:[1,0]
    s_nop 0
    v_rcp_f32 v96, v96
    buffer_load_dword v62, v62, s[20:23], 0 offen sc1
    s_waitcnt lgkmcnt(9)
    buffer_load_dword v70, v70, s[20:23], 0 offen sc1
    ds_read_u16_d16_hi v81, v81
    v_rcp_f32 v99, v99
    v_mad_u32_u16 v84, v84, 2, s36 op_sel:[1,0,0,0]
    ds_read_u16_d16_hi v80, v80
    v_mad_u32_u16 v87, v87, 2, s36 op_sel:[1,0,0,0]
    buffer_load_dword v68, v68, s[20:23], 0 offen sc1
    v_rcp_f32 v95, v95
    v_mad_u32_u16 v85, v85, 2, s36 op_sel:[1,0,0,0]
    v_rcp_f32 v97, v97
    v_rcp_f32 v94, v94
    buffer_load_dword v72, v72, s[20:23], 0 offen sc1
    buffer_load_dword v74, v74, s[20:23], 0 offen sc1
    ds_read_u16 v84, v84
    ds_read_u16_d16_hi v82, v82
    buffer_load_dword v69, v69, s[20:23], 0 offen sc1
    v_rcp_f32 v93, v93
    v_rcp_f32 v98, v98
    s_waitcnt lgkmcnt(2)
    v_lshl_add_u64 v[76:77], v[76:77], 0, v[80:81]
    v_mad_u32_u16 v83, v83, 2, s36 op_sel:[1,0,0,0]
    v_rcp_f32 v92, v92
    ds_read_u16_d16_hi v83, v83
    v_pk_mul_f32 v[96:97], v[96:97], v[48:49]
    v_pk_mul_f32 v[92:93], v[92:93], v[44:45]
    v_pk_mul_f32 v[94:95], v[94:95], v[46:47]
    v_mad_u32_u16 v86, v86, 2, s36 op_sel:[1,0,0,0]
    v_pk_mul_f32 v[98:99], v[98:99], v[50:51]
    v_mad_u32_u16 v90, v90, 2, s36 op_sel:[1,0,0,0]
    v_cvt_pk_bf16_f32 v93, v93, v97
    v_cvt_pk_bf16_f32 v94, v94, v98
    ds_read_u16 v85, v85
    buffer_load_dword v66, v66, s[20:23], 0 offen sc1
    v_mad_u32_u16 v88, v88, 2, s36 op_sel:[1,0,0,0]
    buffer_load_dword v71, v71, s[20:23], 0 offen sc1
    v_exp_f32 v98, -v58
    v_cvt_pk_bf16_f32 v92, v92, v96
    v_cvt_pk_bf16_f32 v95, v95, v99
    v_exp_f32 v96, -v56
    s_waitcnt lgkmcnt(1)
    v_lshl_add_u64 v[78:79], v[78:79], 0, v[82:83]
    ds_read_b128 v[116:119], v5
    v_exp_f32 v99, -v59
    ds_read_u16_d16_hi v4, v8 offset:130
    v_mfma_f32_32x32x16_bf16 v[28:43], v[108:111], v[92:95], v[28:43]
    v_exp_f32 v94, -v54
    v_exp_f32 v95, -v55
    v_exp_f32 v97, -v57
    ds_read_u16_d16_hi v90, v90
    ds_read_u16 v87, v87
    v_exp_f32 v92, -v52
    v_pk_add_f32 v[96:97], v[96:97], 1.0 op_sel_hi:[1,0]
    v_pk_add_f32 v[94:95], v[94:95], 1.0 op_sel_hi:[1,0]
    v_exp_f32 v93, -v53
    v_pk_add_f32 v[98:99], v[98:99], 1.0 op_sel_hi:[1,0]
    v_rcp_f32 v94, v94
    buffer_load_dword v75, v75, s[20:23], 0 offen sc1
    ds_read_u16 v86, v86
    v_rcp_f32 v98, v98
    v_mad_u32_u16 v91, v91, 2, s36 op_sel:[1,0,0,0]
    ds_read_u16_d16_hi v88, v88
    ds_read_u16_d16_hi v89, v89
    v_pk_add_f32 v[92:93], v[92:93], 1.0 op_sel_hi:[1,0]
    v_mfma_f32_32x32x16_bf16 v[12:27], v[108:111], v[76:79], v[12:27]
    v_rcp_f32 v96, v96
    v_rcp_f32 v92, v92
    v_rcp_f32 v93, v93
    ds_read_u16_d16_hi v91, v91
    v_rcp_f32 v97, v97
    v_rcp_f32 v99, v99
    v_pk_mul_f32 v[96:97], v[96:97], v[56:57]
    v_pk_mul_f32 v[92:93], v[92:93], v[52:53]
    v_pk_mul_f32 v[98:99], v[98:99], v[58:59]
    s_waitcnt lgkmcnt(1)
    v_lshl_add_u64 v[84:85], v[84:85], 0, v[88:89]
    ds_read_b128 v[48:51], v6 offset:272
    v_rcp_f32 v95, v95
    s_waitcnt lgkmcnt(1)
L_ic5:
    s_cbranch_execz L_icr
    v_lshl_add_u64 v[86:87], v[86:87], 0, v[90:91]
    v_pk_mul_f32 v[94:95], v[94:95], v[54:55]
    ds_read_b128 v[44:47], v6 offset:256
    v_mfma_f32_32x32x16_bf16 v[12:27], v[112:115], v[84:87], v[12:27]
    v_cvt_pk_bf16_f32 v95, v95, v99
    v_cvt_pk_bf16_f32 v92, v92, v96
    v_cvt_pk_bf16_f32 v94, v94, v98
    v_cvt_pk_bf16_f32 v93, v93, v97
    s_nop 1
    v_mfma_f32_32x32x16_bf16 v[28:43], v[112:115], v[92:95], v[28:43]
    ds_read_b128 v[56:59], v6 offset:304
    ds_read_b128 v[52:55], v6 offset:288
    s_sub_u32 s38, s38, 1
    s_cmp_gt_u32 s38, 3
    s_cbranch_scc1 L_go1
    s_setprio 2
    s_cmp_eq_u32 s38, 3
    s_cbranch_scc1 L_go1
    s_setprio 1
    s_cmp_eq_u32 s38, 1
    s_cbranch_scc1 L_last1
L_go1:
    s_waitcnt vmcnt(0)
    v_lshlrev_b64 v[80:81], 16, v[64:65]
    v_lshlrev_b64 v[82:83], 16, v[66:67]
    s_waitcnt lgkmcnt(2)
    buffer_load_dword v45, v45, s[20:23], 0 offen sc1
    v_add_u32_dpp v114, v4, v9 quad_perm:[3,3,3,3] row_mask:0xf bank_mask:0xf bound_ctrl:1
    v_mad_u32_u24 v5, s37, v0, v7
    v_lshlrev_b64 v[90:91], 16, v[74:75]
    v_lshlrev_b64 v[76:77], 16, v[60:61]
    v_lshlrev_b64 v[86:87], 16, v[70:71]
    v_lshlrev_b64 v[88:89], 16, v[72:73]
    v_lshlrev_b64 v[78:79], 16, v[62:63]
    v_lshlrev_b64 v[84:85], 16, v[68:69]
    s_mov_b32 exec_hi, 0
    ds_read_u8 v5, v5 offset:3
    s_mov_b32 exec_hi, -1
    s_add_u32 s37, s37, 1
    v_mfma_f32_32x32x16_bf16 v[76:91], v[116:119], v[120:123], v[76:91]
    v_add_u32_dpp v110, v4, v9 quad_perm:[1,1,1,1] row_mask:0xf bank_mask:0xf bound_ctrl:1
    v_add_u32_dpp v112, v4, v9 quad_perm:[2,2,2,2] row_mask:0xf bank_mask:0xf bound_ctrl:1
    v_add_u32_dpp v108, v4, v9 quad_perm:[0,0,0,0] row_mask:0xf bank_mask:0xf bound_ctrl:1
    ds_read_b64_tr_b16 v[114:115], v114 offset:672
    ds_read_b64_tr_b16 v[110:111], v110 offset:544
    buffer_load_dword v49, v49, s[20:23], 0 offen sc1
    ds_read_b64_tr_b16 v[108:109], v108 offset:512
    v_mfma_f32_32x32x16_bf16 v[60:75], v[116:119], v[124:127], v[60:75]
    s_nop 3
    v_mad_u32_u16 v78, v78, 2, s36 op_sel:[1,0,0,0]
    v_mad_u32_u16 v77, v77, 2, s36 op_sel:[1,0,0,0]
    v_mad_u32_u16 v89, v89, 2, s36 op_sel:[1,0,0,0]
    v_mad_u32_u16 v79, v79, 2, s36 op_sel:[1,0,0,0]
    ds_read_u16 v77, v77
    ds_read_u16 v78, v78
    s_nop 1
    v_exp_f32 v94, -v62
    v_exp_f32 v93, -v61
    v_mad_u32_u16 v76, v76, 2, s36 op_sel:[1,0,0,0]
    v_exp_f32 v97, -v65
    v_exp_f32 v98, -v66
    ds_read_b64_tr_b16 v[112:113], v112 offset:640
    ds_read_u16 v79, v79
    v_mad_u32_u16 v81, v81, 2, s36 op_sel:[1,0,0,0]
    v_exp_f32 v99, -v67
    v_mad_u32_u16 v82, v82, 2, s36 op_sel:[1,0,0,0]
    buffer_load_dword v47, v47, s[20:23], 0 offen sc1
    buffer_load_dword v44, v44, s[20:23], 0 offen sc1
    v_exp_f32 v95, -v63
    v_exp_f32 v92, -v60
    ds_read_u16 v76, v76
    s_waitcnt lgkmcnt(10)
    buffer_load_dword v57, v57, s[20:23], 0 offen sc1
    buffer_load_dword v51, v51, s[20:23], 0 offen sc1
    v_mad_u32_u16 v80, v80, 2, s36 op_sel:[1,0,0,0]
    v_exp_f32 v96, -v64
    buffer_load_dword v48, v48, s[20:23], 0 offen sc1
    v_pk_add_f32 v[94:95], v[94:95], 1.0 op_sel_hi:[1,0]
    v_pk_add_f32 v[98:99], v[98:99], 1.0 op_sel_hi:[1,0]
    v_pk_add_f32 v[92:93], v[92:93], 1.0 op_sel_hi:[1,0]
    v_pk_add_f32 v[96:97], v[96:97], 1.0 op_sel_hi:[1,0]
    s_nop 0
    v_rcp_f32 v96, v96
    buffer_load_dword v46, v46, s[20:23], 0 offen sc1
    s_waitcnt lgkmcnt(9)
    buffer_load_dword v54, v54, s[20:23], 0 offen sc1
    ds_read_u16_d16_hi v81, v81
    v_rcp_f32 v99, v99
    v_mad_u32_u16 v84, v84, 2, s36 op_sel:[1,0,0,0]
    ds_read_u16_d16_hi v80, v80
    v_mad_u32_u16 v87, v87, 2, s36 op_sel:[1,0,0,0]
    buffer_load_dword v52, v52, s[20:23], 0 offen sc1
    v_rcp_f32 v95, v95
    v_mad_u32_u16 v85, v85, 2, s36 op_sel:[1,0,0,0]
    v_rcp_f32 v97, v97
    v_rcp_f32 v94, v94
    buffer_load_dword v56, v56, s[20:23], 0 offen sc1
    buffer_load_dword v58, v58, s[20:23], 0 offen sc1
    ds_read_u16 v84, v84
    ds_read_u16_d16_hi v82, v82
    buffer_load_dword v53, v53, s[20:23], 0 offen sc1
    v_rcp_f32 v93, v93
    v_rcp_f32 v98, v98
    s_waitcnt lgkmcnt(2)
    v_lshl_add_u64 v[76:77], v[76:77], 0, v[80:81]
    v_mad_u32_u16 v83, v83, 2, s36 op_sel:[1,0,0,0]
    v_rcp_f32 v92, v92
    ds_read_u16_d16_hi v83, v83
    v_pk_mul_f32 v[96:97], v[96:97], v[64:65]
    v_pk_mul_f32 v[92:93], v[92:93], v[60:61]
    v_pk_mul_f32 v[94:95], v[94:95], v[62:63]
    v_mad_u32_u16 v86, v86, 2, s36 op_sel:[1,0,0,0]
    v_pk_mul_f32 v[98:99], v[98:99], v[66:67]
    v_mad_u32_u16 v90, v90, 2, s36 op_sel:[1,0,0,0]
    v_cvt_pk_bf16_f32 v93, v93, v97
    v_cvt_pk_bf16_f32 v94, v94, v98
    ds_read_u16 v85, v85
    buffer_load_dword v50, v50, s[20:23], 0 offen sc1
    v_mad_u32_u16 v88, v88, 2, s36 op_sel:[1,0,0,0]
    buffer_load_dword v55, v55, s[20:23], 0 offen sc1
    v_exp_f32 v98, -v74
    v_cvt_pk_bf16_f32 v92, v92, v96
    v_cvt_pk_bf16_f32 v95, v95, v99
    v_exp_f32 v96, -v72
    s_waitcnt lgkmcnt(1)
    v_lshl_add_u64 v[78:79], v[78:79], 0, v[82:83]
    ds_read_b128 v[116:119], v5
    v_exp_f32 v99, -v75
    ds_read_u16_d16_hi v4, v8 offset:258
    v_mfma_f32_32x32x16_bf16 v[28:43], v[108:111], v[92:95], v[28:43]
    v_exp_f32 v94, -v70
    v_exp_f32 v95, -v71
    v_exp_f32 v97, -v73
    ds_read_u16_d16_hi v90, v90
    ds_read_u16 v87, v87
    v_exp_f32 v92, -v68
    v_pk_add_f32 v[96:97], v[96:97], 1.0 op_sel_hi:[1,0]
    v_pk_add_f32 v[94:95], v[94:95], 1.0 op_sel_hi:[1,0]
    v_exp_f32 v93, -v69
    v_pk_add_f32 v[98:99], v[98:99], 1.0 op_sel_hi:[1,0]
    v_rcp_f32 v94, v94
    buffer_load_dword v59, v59, s[20:23], 0 offen sc1
    ds_read_u16 v86, v86
    v_rcp_f32 v98, v98
    v_mad_u32_u16 v91, v91, 2, s36 op_sel:[1,0,0,0]
    ds_read_u16_d16_hi v88, v88
    ds_read_u16_d16_hi v89, v89
L_ic6:
    s_cbranch_execz L_icr
    v_pk_add_f32 v[92:93], v[92:93], 1.0 op_sel_hi:[1,0]
    v_mfma_f32_32x32x16_bf16 v[12:27], v[108:111], v[76:79], v[12:27]
    v_rcp_f32 v96, v96
    v_rcp_f32 v92, v92
    v_rcp_f32 v93, v93
    ds_read_u16_d16_hi v91, v91
    v_rcp_f32 v97, v97
    v_rcp_f32 v99, v99
    v_pk_mul_f32 v[96:97], v[96:97], v[72:73]
    v_pk_mul_f32 v[92:93], v[92:93], v[68:69]
    v_pk_mul_f32 v[98:99], v[98:99], v[74:75]
    s_waitcnt lgkmcnt(1)
    v_lshl_add_u64 v[84:85], v[84:85], 0, v[88:89]
    ds_read_b128 v[64:67], v6 offset:400
    v_rcp_f32 v95, v95
    s_waitcnt lgkmcnt(1)
    v_lshl_add_u64 v[86:87], v[86:87], 0, v[90:91]
    v_pk_mul_f32 v[94:95], v[94:95], v[70:71]
    ds_read_b128 v[60:63], v6 offset:384
    v_mfma_f32_32x32x16_bf16 v[12:27], v[112:115], v[84:87], v[12:27]
    v_cvt_pk_bf16_f32 v95, v95, v99
    v_cvt_pk_bf16_f32 v92, v92, v96
    v_cvt_pk_bf16_f32 v94, v94, v98
    v_cvt_pk_bf16_f32 v93, v93, v97
    s_nop 1
    v_mfma_f32_32x32x16_bf16 v[28:43], v[112:115], v[92:95], v[28:43]
    v_add_u32 v8, 256, v8
    v_add_u32 v9, 1024, v9
    ds_read_b128 v[72:75], v6 offset:432
    ds_read_b128 v[68:71], v6 offset:416
    v_add_u32 v6, 256, v6
    s_sub_u32 s38, s38, 1
    s_branch L_mloop
L_last1:
    s_setprio 0
    s_waitcnt vmcnt(0)
    v_lshlrev_b64 v[80:81], 16, v[64:65]
    v_lshlrev_b64 v[82:83], 16, v[66:67]
    v_add_u32_dpp v114, v4, v9 quad_perm:[3,3,3,3] row_mask:0xf bank_mask:0xf bound_ctrl:1
    v_lshlrev_b64 v[90:91], 16, v[74:75]
    v_lshlrev_b64 v[76:77], 16, v[60:61]
    v_lshlrev_b64 v[86:87], 16, v[70:71]
    v_lshlrev_b64 v[88:89], 16, v[72:73]
    v_lshlrev_b64 v[78:79], 16, v[62:63]
    v_lshlrev_b64 v[84:85], 16, v[68:69]
    s_nop 1
    v_mfma_f32_32x32x16_bf16 v[76:91], v[116:119], v[120:123], v[76:91]
    s_add_u32 s56, s66, s3
    s_sub_u32 s58, 1, s63
    s_and_b32 s58, s58, 7
    s_cmp_le_u32 s58, s67
    s_cselect_b32 s41, -1, 0
    s_sub_u32 s58, s58, 1
    s_cmp_le_u32 s58, s67
    s_cselect_b32 s40, -1, 0
    s_add_u32 s58, s58, s56
    s_mul_i32 s58, s58, 272
    s_add_u32 s48, s58, 2368
    s_sub_u32 s58, 3, s63
    s_and_b32 s58, s58, 7
    s_cmp_le_u32 s58, s67
    s_cselect_b32 s43, -1, 0
    s_sub_u32 s58, s58, 1
    s_cmp_le_u32 s58, s67
    s_cselect_b32 s42, -1, 0
    s_add_u32 s58, s58, s56
    s_mul_i32 s58, s58, 272
    s_add_u32 s49, s58, 2368
    v_add_u32_dpp v110, v4, v9 quad_perm:[1,1,1,1] row_mask:0xf bank_mask:0xf bound_ctrl:1
    v_add_u32_dpp v112, v4, v9 quad_perm:[2,2,2,2] row_mask:0xf bank_mask:0xf bound_ctrl:1
    v_add_u32_dpp v108, v4, v9 quad_perm:[0,0,0,0] row_mask:0xf bank_mask:0xf bound_ctrl:1
    ds_read_b64_tr_b16 v[114:115], v114 offset:672
    ds_read_b64_tr_b16 v[110:111], v110 offset:544
    ds_read_b64_tr_b16 v[108:109], v108 offset:512
    v_mfma_f32_32x32x16_bf16 v[60:75], v[116:119], v[124:127], v[60:75]
    s_sub_u32 s58, 5, s63
    s_and_b32 s58, s58, 7
    s_cmp_le_u32 s58, s67
    s_cselect_b32 s45, -1, 0
    s_sub_u32 s58, s58, 1
    s_cmp_le_u32 s58, s67
    s_cselect_b32 s44, -1, 0
    s_add_u32 s58, s58, s56
    s_mul_i32 s58, s58, 272
    s_add_u32 s50, s58, 2368
    s_sub_u32 s58, 7, s63
    s_and_b32 s58, s58, 7
    s_cmp_le_u32 s58, s67
    s_cselect_b32 s47, -1, 0
    s_sub_u32 s58, s58, 1
    s_cmp_le_u32 s58, s67
    s_cselect_b32 s46, -1, 0
    s_add_u32 s58, s58, s56
    s_mul_i32 s58, s58, 272
    s_add_u32 s51, s58, 2368
    v_mad_u32_u16 v78, v78, 2, s36 op_sel:[1,0,0,0]
    v_mad_u32_u16 v77, v77, 2, s36 op_sel:[1,0,0,0]
    v_mad_u32_u16 v89, v89, 2, s36 op_sel:[1,0,0,0]
    v_mad_u32_u16 v79, v79, 2, s36 op_sel:[1,0,0,0]
    ds_read_u16 v77, v77
    ds_read_u16 v78, v78
    v_exp_f32 v94, -v62
    v_exp_f32 v93, -v61
    v_mad_u32_u16 v76, v76, 2, s36 op_sel:[1,0,0,0]
    v_exp_f32 v97, -v65
    v_exp_f32 v98, -v66
    ds_read_b64_tr_b16 v[112:113], v112 offset:640
    ds_read_u16 v79, v79
    v_mad_u32_u16 v81, v81, 2, s36 op_sel:[1,0,0,0]
    v_exp_f32 v99, -v67
    v_mad_u32_u16 v82, v82, 2, s36 op_sel:[1,0,0,0]
    v_exp_f32 v95, -v63
    v_exp_f32 v92, -v60
    ds_read_u16 v76, v76
    v_mad_u32_u16 v80, v80, 2, s36 op_sel:[1,0,0,0]
    v_exp_f32 v96, -v64
    v_pk_add_f32 v[94:95], v[94:95], 1.0 op_sel_hi:[1,0]
L_ic7:
    s_cbranch_execz L_icr
    v_pk_add_f32 v[98:99], v[98:99], 1.0 op_sel_hi:[1,0]
    v_pk_add_f32 v[92:93], v[92:93], 1.0 op_sel_hi:[1,0]
    v_pk_add_f32 v[96:97], v[96:97], 1.0 op_sel_hi:[1,0]
    s_nop 0
    v_rcp_f32 v96, v96
    ds_read_u16_d16_hi v81, v81
    v_rcp_f32 v99, v99
    v_mad_u32_u16 v84, v84, 2, s36 op_sel:[1,0,0,0]
    ds_read_u16_d16_hi v80, v80
    v_mad_u32_u16 v87, v87, 2, s36 op_sel:[1,0,0,0]
    v_rcp_f32 v95, v95
    v_mad_u32_u16 v85, v85, 2, s36 op_sel:[1,0,0,0]
    v_rcp_f32 v97, v97
    v_rcp_f32 v94, v94
    ds_read_u16 v84, v84
    ds_read_u16_d16_hi v82, v82
    v_rcp_f32 v93, v93
    v_rcp_f32 v98, v98
    s_waitcnt lgkmcnt(2)
    v_lshl_add_u64 v[76:77], v[76:77], 0, v[80:81]
    v_mad_u32_u16 v83, v83, 2, s36 op_sel:[1,0,0,0]
    v_rcp_f32 v92, v92
    ds_read_u16_d16_hi v83, v83
    v_pk_mul_f32 v[96:97], v[96:97], v[64:65]
    v_pk_mul_f32 v[92:93], v[92:93], v[60:61]
    v_pk_mul_f32 v[94:95], v[94:95], v[62:63]
    v_mad_u32_u16 v86, v86, 2, s36 op_sel:[1,0,0,0]
    v_pk_mul_f32 v[98:99], v[98:99], v[66:67]
    v_mad_u32_u16 v90, v90, 2, s36 op_sel:[1,0,0,0]
    v_cvt_pk_bf16_f32 v93, v93, v97
    v_cvt_pk_bf16_f32 v94, v94, v98
    ds_read_u16 v85, v85
    v_mad_u32_u16 v88, v88, 2, s36 op_sel:[1,0,0,0]
    v_exp_f32 v98, -v74
    v_cvt_pk_bf16_f32 v92, v92, v96
    v_cvt_pk_bf16_f32 v95, v95, v99
    v_exp_f32 v96, -v72
    s_waitcnt lgkmcnt(1)
    v_lshl_add_u64 v[78:79], v[78:79], 0, v[82:83]
    v_exp_f32 v99, -v75
    v_mfma_f32_32x32x16_bf16 v[28:43], v[108:111], v[92:95], v[28:43]
    v_exp_f32 v94, -v70
    v_exp_f32 v95, -v71
    v_exp_f32 v97, -v73
    ds_read_u16_d16_hi v90, v90
    ds_read_u16 v87, v87
    v_exp_f32 v92, -v68
    v_pk_add_f32 v[96:97], v[96:97], 1.0 op_sel_hi:[1,0]
    v_pk_add_f32 v[94:95], v[94:95], 1.0 op_sel_hi:[1,0]
    v_exp_f32 v93, -v69
    v_pk_add_f32 v[98:99], v[98:99], 1.0 op_sel_hi:[1,0]
    v_rcp_f32 v94, v94
    ds_read_u16 v86, v86
    v_rcp_f32 v98, v98
    v_mad_u32_u16 v91, v91, 2, s36 op_sel:[1,0,0,0]
    ds_read_u16_d16_hi v88, v88
    ds_read_u16_d16_hi v89, v89
    v_pk_add_f32 v[92:93], v[92:93], 1.0 op_sel_hi:[1,0]
    v_mfma_f32_32x32x16_bf16 v[12:27], v[108:111], v[76:79], v[12:27]
    v_rcp_f32 v96, v96
    v_rcp_f32 v92, v92
    v_rcp_f32 v93, v93
    ds_read_u16_d16_hi v91, v91
    v_rcp_f32 v97, v97
    v_rcp_f32 v99, v99
    v_pk_mul_f32 v[96:97], v[96:97], v[72:73]
    v_pk_mul_f32 v[92:93], v[92:93], v[68:69]
    v_pk_mul_f32 v[98:99], v[98:99], v[74:75]
    s_waitcnt lgkmcnt(1)
    v_lshl_add_u64 v[84:85], v[84:85], 0, v[88:89]
    v_rcp_f32 v95, v95
    s_waitcnt lgkmcnt(0)
    v_lshl_add_u64 v[86:87], v[86:87], 0, v[90:91]
    v_pk_mul_f32 v[94:95], v[94:95], v[70:71]
    s_nop 0
    v_mfma_f32_32x32x16_bf16 v[12:27], v[112:115], v[84:87], v[12:27]
    v_cvt_pk_bf16_f32 v95, v95, v99
    v_cvt_pk_bf16_f32 v92, v92, v96
    v_cvt_pk_bf16_f32 v94, v94, v98
    v_cvt_pk_bf16_f32 v93, v93, v97
    s_nop 1
    v_mfma_f32_32x32x16_bf16 v[28:43], v[112:115], v[92:95], v[28:43]
    s_branch L_mdone
L_psh:
    s_lshr_b32 s58, s3, 2
    s_lshl_b32 s58, s58, 4
    v_and_or_b32 v80, v3, 15, s58
    v_lshlrev_b32 v80, 2, v80
    ds_read_b32 v80, v80 offset:1536
    s_brev_b32 s59, 2
    s_waitcnt lgkmcnt(0)
    v_bcnt_u32_b32 v80, v80, -2
L_plh:
    v_subrev_u32 v80, 1, v80
    v_add_u32 v107, 272, v107
    v_and_or_b32 v107, v80, s59, v107
    v_cmp_lt_i32 vcc, 0, v80
    ds_read_b128 v[28:31], v107 offset:2640
    ds_read_b128 v[32:35], v107 offset:2704
    s_waitcnt lgkmcnt(1)
    v_mfma_f32_16x16x32_bf16 v[92:95], v[28:31], v[52:55], v[92:95]
    s_waitcnt lgkmcnt(0)
    v_mfma_f32_16x16x32_bf16 v[92:95], v[32:35], v[56:59], v[92:95]
    s_cbranch_vccnz L_plh
    s_nop 7
    s_branch L_pdh
L_psp:
    s_sub_u32 s58, s3, 12
    s_lshl_b32 s58, s58, 6
    v_and_or_b32 v80, v3, 60, s58
    ds_read_b32 v80, v80 offset:1536
    s_brev_b32 s59, 2
    s_waitcnt lgkmcnt(0)
    v_bcnt_u32_b32 v80, v80, -2
L_plp:
    v_subrev_u32 v80, 1, v80
    v_add_u32 v107, 272, v107
    v_and_or_b32 v107, v80, s59, v107
    v_cmp_lt_i32 vcc, 0, v80
    ds_read_b128 v[28:31], v107 offset:2768
    ds_read_b128 v[32:35], v107 offset:2832
    s_waitcnt lgkmcnt(1)
    v_pk_add_f32 v[12:13], v[12:13], v[28:29]
    v_pk_add_f32 v[14:15], v[14:15], v[30:31]
    s_waitcnt lgkmcnt(0)
    v_pk_add_f32 v[16:17], v[16:17], v[32:33]
    v_pk_add_f32 v[18:19], v[18:19], v[34:35]
    s_cbranch_vccnz L_plp
    s_nop 7
    s_branch L_pdp
.p2align 12
L_ic8:
    s_cbranch_execz L_icr
L_last0:
    s_setprio 0
    s_waitcnt vmcnt(0)
    v_lshlrev_b64 v[80:81], 16, v[48:49]
    v_lshlrev_b64 v[82:83], 16, v[50:51]
    v_add_u32_dpp v114, v4, v9 quad_perm:[3,3,3,3] row_mask:0xf bank_mask:0xf bound_ctrl:1
    v_lshlrev_b64 v[90:91], 16, v[58:59]
    v_lshlrev_b64 v[76:77], 16, v[44:45]
    v_lshlrev_b64 v[86:87], 16, v[54:55]
    v_lshlrev_b64 v[88:89], 16, v[56:57]
    v_lshlrev_b64 v[78:79], 16, v[46:47]
    v_lshlrev_b64 v[84:85], 16, v[52:53]
    s_nop 1
    v_mfma_f32_32x32x16_bf16 v[76:91], v[116:119], v[120:123], v[76:91]
    s_add_u32 s56, s66, s3
    s_sub_u32 s58, 1, s63
    s_and_b32 s58, s58, 7
    s_cmp_le_u32 s58, s67
    s_cselect_b32 s41, -1, 0
    s_sub_u32 s58, s58, 1
    s_cmp_le_u32 s58, s67
    s_cselect_b32 s40, -1, 0
    s_add_u32 s58, s58, s56
    s_mul_i32 s58, s58, 272
    s_add_u32 s48, s58, 2368
    s_sub_u32 s58, 3, s63
    s_and_b32 s58, s58, 7
    s_cmp_le_u32 s58, s67
    s_cselect_b32 s43, -1, 0
    s_sub_u32 s58, s58, 1
    s_cmp_le_u32 s58, s67
    s_cselect_b32 s42, -1, 0
    s_add_u32 s58, s58, s56
    s_mul_i32 s58, s58, 272
    s_add_u32 s49, s58, 2368
    v_add_u32_dpp v110, v4, v9 quad_perm:[1,1,1,1] row_mask:0xf bank_mask:0xf bound_ctrl:1
    v_add_u32_dpp v112, v4, v9 quad_perm:[2,2,2,2] row_mask:0xf bank_mask:0xf bound_ctrl:1
    v_add_u32_dpp v108, v4, v9 quad_perm:[0,0,0,0] row_mask:0xf bank_mask:0xf bound_ctrl:1
    ds_read_b64_tr_b16 v[114:115], v114 offset:160
    ds_read_b64_tr_b16 v[110:111], v110 offset:32
    ds_read_b64_tr_b16 v[108:109], v108 offset:0
    v_mfma_f32_32x32x16_bf16 v[44:59], v[116:119], v[124:127], v[44:59]
    s_sub_u32 s58, 5, s63
    s_and_b32 s58, s58, 7
    s_cmp_le_u32 s58, s67
    s_cselect_b32 s45, -1, 0
    s_sub_u32 s58, s58, 1
    s_cmp_le_u32 s58, s67
    s_cselect_b32 s44, -1, 0
    s_add_u32 s58, s58, s56
    s_mul_i32 s58, s58, 272
    s_add_u32 s50, s58, 2368
    s_sub_u32 s58, 7, s63
    s_and_b32 s58, s58, 7
    s_cmp_le_u32 s58, s67
    s_cselect_b32 s47, -1, 0
    s_sub_u32 s58, s58, 1
    s_cmp_le_u32 s58, s67
    s_cselect_b32 s46, -1, 0
    s_add_u32 s58, s58, s56
    s_mul_i32 s58, s58, 272
    s_add_u32 s51, s58, 2368
    v_mad_u32_u16 v78, v78, 2, s36 op_sel:[1,0,0,0]
    v_mad_u32_u16 v77, v77, 2, s36 op_sel:[1,0,0,0]
    v_mad_u32_u16 v89, v89, 2, s36 op_sel:[1,0,0,0]
    v_mad_u32_u16 v79, v79, 2, s36 op_sel:[1,0,0,0]
    ds_read_u16 v77, v77
    ds_read_u16 v78, v78
    v_exp_f32 v94, -v46
    v_exp_f32 v93, -v45
    v_mad_u32_u16 v76, v76, 2, s36 op_sel:[1,0,0,0]
    v_exp_f32 v97, -v49
    v_exp_f32 v98, -v50
    ds_read_b64_tr_b16 v[112:113], v112 offset:128
    ds_read_u16 v79, v79
    v_mad_u32_u16 v81, v81, 2, s36 op_sel:[1,0,0,0]
    v_exp_f32 v99, -v51
    v_mad_u32_u16 v82, v82, 2, s36 op_sel:[1,0,0,0]
    v_exp_f32 v95, -v47
    v_exp_f32 v92, -v44
    ds_read_u16 v76, v76
    v_mad_u32_u16 v80, v80, 2, s36 op_sel:[1,0,0,0]
    v_exp_f32 v96, -v48
    v_pk_add_f32 v[94:95], v[94:95], 1.0 op_sel_hi:[1,0]
    v_pk_add_f32 v[98:99], v[98:99], 1.0 op_sel_hi:[1,0]
    v_pk_add_f32 v[92:93], v[92:93], 1.0 op_sel_hi:[1,0]
    v_pk_add_f32 v[96:97], v[96:97], 1.0 op_sel_hi:[1,0]
    s_nop 0
    v_rcp_f32 v96, v96
    ds_read_u16_d16_hi v81, v81
    v_rcp_f32 v99, v99
    v_mad_u32_u16 v84, v84, 2, s36 op_sel:[1,0,0,0]
    ds_read_u16_d16_hi v80, v80
    v_mad_u32_u16 v87, v87, 2, s36 op_sel:[1,0,0,0]
    v_rcp_f32 v95, v95
    v_mad_u32_u16 v85, v85, 2, s36 op_sel:[1,0,0,0]
    v_rcp_f32 v97, v97
    v_rcp_f32 v94, v94
    ds_read_u16 v84, v84
    ds_read_u16_d16_hi v82, v82
    v_rcp_f32 v93, v93
    v_rcp_f32 v98, v98
    s_waitcnt lgkmcnt(2)
    v_lshl_add_u64 v[76:77], v[76:77], 0, v[80:81]
    v_mad_u32_u16 v83, v83, 2, s36 op_sel:[1,0,0,0]
    v_rcp_f32 v92, v92
    ds_read_u16_d16_hi v83, v83
    v_pk_mul_f32 v[96:97], v[96:97], v[48:49]
    v_pk_mul_f32 v[92:93], v[92:93], v[44:45]
    v_pk_mul_f32 v[94:95], v[94:95], v[46:47]
    v_mad_u32_u16 v86, v86, 2, s36 op_sel:[1,0,0,0]
    v_pk_mul_f32 v[98:99], v[98:99], v[50:51]
    v_mad_u32_u16 v90, v90, 2, s36 op_sel:[1,0,0,0]
    v_cvt_pk_bf16_f32 v93, v93, v97
    v_cvt_pk_bf16_f32 v94, v94, v98
    ds_read_u16 v85, v85
    v_mad_u32_u16 v88, v88, 2, s36 op_sel:[1,0,0,0]
    v_exp_f32 v98, -v58
    v_cvt_pk_bf16_f32 v92, v92, v96
    v_cvt_pk_bf16_f32 v95, v95, v99
    v_exp_f32 v96, -v56
    s_waitcnt lgkmcnt(1)
    v_lshl_add_u64 v[78:79], v[78:79], 0, v[82:83]
    v_exp_f32 v99, -v59
    v_mfma_f32_32x32x16_bf16 v[28:43], v[108:111], v[92:95], v[28:43]
    v_exp_f32 v94, -v54
    v_exp_f32 v95, -v55
    v_exp_f32 v97, -v57
    ds_read_u16_d16_hi v90, v90
    ds_read_u16 v87, v87
    v_exp_f32 v92, -v52
    v_pk_add_f32 v[96:97], v[96:97], 1.0 op_sel_hi:[1,0]
    v_pk_add_f32 v[94:95], v[94:95], 1.0 op_sel_hi:[1,0]
    v_exp_f32 v93, -v53
    v_pk_add_f32 v[98:99], v[98:99], 1.0 op_sel_hi:[1,0]
    v_rcp_f32 v94, v94
    ds_read_u16 v86, v86
    v_rcp_f32 v98, v98
    v_mad_u32_u16 v91, v91, 2, s36 op_sel:[1,0,0,0]
    ds_read_u16_d16_hi v88, v88
    ds_read_u16_d16_hi v89, v89
    v_pk_add_f32 v[92:93], v[92:93], 1.0 op_sel_hi:[1,0]
    v_mfma_f32_32x32x16_bf16 v[12:27], v[108:111], v[76:79], v[12:27]
    v_rcp_f32 v96, v96
    v_rcp_f32 v92, v92
    v_rcp_f32 v93, v93
    ds_read_u16_d16_hi v91, v91
    v_rcp_f32 v97, v97
    v_rcp_f32 v99, v99
    v_pk_mul_f32 v[96:97], v[96:97], v[56:57]
    v_pk_mul_f32 v[92:93], v[92:93], v[52:53]
    v_pk_mul_f32 v[98:99], v[98:99], v[58:59]
    s_waitcnt lgkmcnt(1)
    v_lshl_add_u64 v[84:85], v[84:85], 0, v[88:89]
    v_rcp_f32 v95, v95
    s_waitcnt lgkmcnt(0)
    v_lshl_add_u64 v[86:87], v[86:87], 0, v[90:91]
    v_pk_mul_f32 v[94:95], v[94:95], v[54:55]
    s_nop 0
    v_mfma_f32_32x32x16_bf16 v[12:27], v[112:115], v[84:87], v[12:27]
L_ic9:
    s_cbranch_execz L_icr
    v_cvt_pk_bf16_f32 v95, v95, v99
    v_cvt_pk_bf16_f32 v92, v92, v96
    v_cvt_pk_bf16_f32 v94, v94, v98
    v_cvt_pk_bf16_f32 v93, v93, v97
    s_nop 1
    v_mfma_f32_32x32x16_bf16 v[28:43], v[112:115], v[92:95], v[28:43]
L_mdone:
L_tail:
    s_waitcnt vmcnt(0) lgkmcnt(0)
    s_and_b32 s57, s3, 3
    s_lshl_b32 s59, s57, 12
    s_add_u32 s59, s59, 1310720
    s_cmp_ge_u32 s3, 12
    s_cbranch_scc1 L_nwf
    buffer_load_dwordx4 v[44:47], v2, s[24:27], s59 offen offset:0 sc1
    buffer_load_dwordx4 v[48:51], v2, s[24:27], s59 offen offset:1024 sc1
    buffer_load_dwordx4 v[52:55], v2, s[24:27], s59 offen offset:2048 sc1
    buffer_load_dwordx4 v[56:59], v2, s[24:27], s59 offen offset:3072 sc1
    v_xor_b32 v76, 64, v104
    ds_read_b128 v[60:63], v104
    ds_read_b128 v[64:67], v76
L_nwf:
    s_cmp_eq_u32 s38, 0
    s_cbranch_scc1 L_epi
    s_cmp_eq_u64 s[40:41], 0
    s_cbranch_scc1 L_nfl0
    v_mul_f32 v15, v15, v10
    v_mul_f32 v14, v14, v10
    v_mul_f32 v13, v13, v10
    v_fmac_f32 v15, v31, v11
    v_fmac_f32 v14, v30, v11
    v_fmac_f32 v13, v29, v11
    v_cvt_pk_bf16_f32 v12, v12, v28
    v_add_f32_dpp v15, v15, v15 row_ror:8 row_mask:0xf bank_mask:0xf
    v_add_f32_dpp v14, v14, v14 row_ror:8 row_mask:0xf bank_mask:0xc
    v_add_u32 v28, s48, v1
    s_mov_b64 exec, s[40:41]
    v_add_f32_dpp v14, v13, v13 row_ror:8 row_mask:0xf bank_mask:0x3
    v_add_f32_dpp v15, v15, v15 row_shr:4 row_mask:0xf bank_mask:0x2
    s_nop 1
    v_add_f32_dpp v15, v14, v14 row_shl:4 row_mask:0xf bank_mask:0x5
    ds_write2_b32 v28, v12, v15 offset0:0 offset1:32
    s_mov_b64 exec, -1
L_nfl0:
    s_cmp_eq_u64 s[42:43], 0
    s_cbranch_scc1 L_nfl1
    v_mul_f32 v19, v19, v10
    v_mul_f32 v18, v18, v10
    v_mul_f32 v17, v17, v10
    v_fmac_f32 v19, v35, v11
    v_fmac_f32 v18, v34, v11
    v_fmac_f32 v17, v33, v11
    v_cvt_pk_bf16_f32 v16, v16, v32
    v_add_f32_dpp v19, v19, v19 row_ror:8 row_mask:0xf bank_mask:0xf
    v_add_f32_dpp v18, v18, v18 row_ror:8 row_mask:0xf bank_mask:0xc
    v_add_u32 v32, s49, v1
    s_mov_b64 exec, s[42:43]
    v_add_f32_dpp v18, v17, v17 row_ror:8 row_mask:0xf bank_mask:0x3
    v_add_f32_dpp v19, v19, v19 row_shr:4 row_mask:0xf bank_mask:0x2
    s_nop 1
    v_add_f32_dpp v19, v18, v18 row_shl:4 row_mask:0xf bank_mask:0x5
    ds_write2_b32 v32, v16, v19 offset0:0 offset1:32
    s_mov_b64 exec, -1
L_nfl1:
    s_cmp_eq_u64 s[44:45], 0
    s_cbranch_scc1 L_nfl2
    v_mul_f32 v23, v23, v10
    v_mul_f32 v22, v22, v10
    v_mul_f32 v21, v21, v10
    v_fmac_f32 v23, v39, v11
    v_fmac_f32 v22, v38, v11
    v_fmac_f32 v21, v37, v11
    v_cvt_pk_bf16_f32 v20, v20, v36
    v_add_f32_dpp v23, v23, v23 row_ror:8 row_mask:0xf bank_mask:0xf
    v_add_f32_dpp v22, v22, v22 row_ror:8 row_mask:0xf bank_mask:0xc
    v_add_u32 v36, s50, v1
    s_mov_b64 exec, s[44:45]
    v_add_f32_dpp v22, v21, v21 row_ror:8 row_mask:0xf bank_mask:0x3
    v_add_f32_dpp v23, v23, v23 row_shr:4 row_mask:0xf bank_mask:0x2
    s_nop 1
    v_add_f32_dpp v23, v22, v22 row_shl:4 row_mask:0xf bank_mask:0x5
    ds_write2_b32 v36, v20, v23 offset0:0 offset1:32
    s_mov_b64 exec, -1
L_nfl2:
    s_cmp_eq_u64 s[46:47], 0
    s_cbranch_scc1 L_nfl3
    v_mul_f32 v27, v27, v10
    v_mul_f32 v26, v26, v10
    v_mul_f32 v25, v25, v10
    v_fmac_f32 v27, v43, v11
    v_fmac_f32 v26, v42, v11
    v_fmac_f32 v25, v41, v11
    v_cvt_pk_bf16_f32 v24, v24, v40
    v_add_f32_dpp v27, v27, v27 row_ror:8 row_mask:0xf bank_mask:0xf
    v_add_f32_dpp v26, v26, v26 row_ror:8 row_mask:0xf bank_mask:0xc
    v_add_u32 v40, s51, v1
    s_mov_b64 exec, s[46:47]
    v_add_f32_dpp v26, v25, v25 row_ror:8 row_mask:0xf bank_mask:0x3
    v_add_f32_dpp v27, v27, v27 row_shr:4 row_mask:0xf bank_mask:0x2
    s_nop 1
    v_add_f32_dpp v27, v26, v26 row_shl:4 row_mask:0xf bank_mask:0x5
    ds_write2_b32 v40, v24, v27 offset0:0 offset1:32
    s_mov_b64 exec, -1
L_nfl3:
L_epi:
    s_cmp_ge_u32 s3, 12
    s_cbranch_scc1 L_posw
    s_waitcnt vmcnt(3) lgkmcnt(0)
    v_mfma_f32_16x16x32_bf16 v[92:95], v[60:63], v[44:47], 0
    s_waitcnt vmcnt(2)
    v_mfma_f32_16x16x32_bf16 v[92:95], v[64:67], v[48:51], v[92:95]
    s_nop 7
    v_mul_f32 v92, s62, v92
    v_mul_f32 v93, s62, v93
    v_mul_f32 v94, s62, v94
    v_mul_f32 v95, s62, v95
    s_waitcnt vmcnt(0) lgkmcnt(0)
    s_barrier
    ds_read_b128 v[12:15], v106 offset:2368
    ds_read_b128 v[16:19], v106 offset:2432
    ds_read_b128 v[28:31], v107 offset:2640
    ds_read_b128 v[32:35], v107 offset:2704
    s_waitcnt lgkmcnt(3)
    v_mfma_f32_16x16x32_bf16 v[92:95], v[12:15], v[52:55], v[92:95]
    s_waitcnt lgkmcnt(2)
    v_mfma_f32_16x16x32_bf16 v[92:95], v[16:19], v[56:59], v[92:95]
    s_waitcnt lgkmcnt(1)
    v_mfma_f32_16x16x32_bf16 v[92:95], v[28:31], v[52:55], v[92:95]
    s_waitcnt lgkmcnt(0)
    v_mfma_f32_16x16x32_bf16 v[92:95], v[32:35], v[56:59], v[92:95]
    s_cmp_lg_u64 s[52:53], 0
    s_cbranch_scc1 L_psh
L_pdh:
    s_nop 5
    v_exp_f32 v96, -v92
    v_exp_f32 v97, -v93
    v_exp_f32 v98, -v94
    v_exp_f32 v99, -v95
    v_pk_mul_f32 v[92:93], v[92:93], s[60:61] op_sel_hi:[1,0]
    v_pk_mul_f32 v[94:95], v[94:95], s[60:61] op_sel_hi:[1,0]
    v_pk_add_f32 v[96:97], v[96:97], 1.0 op_sel_hi:[1,0]
    v_pk_add_f32 v[98:99], v[98:99], 1.0 op_sel_hi:[1,0]
    v_rcp_f32 v96, v96
    v_rcp_f32 v97, v97
    v_rcp_f32 v98, v98
    v_rcp_f32 v99, v99
    v_pk_fma_f32 v[100:101], v[92:93], v[96:97], v[100:101]
    v_pk_fma_f32 v[102:103], v[94:95], v[98:99], v[102:103]
    v_cvt_pk_bf16_f32 v100, v100, v101
    v_cvt_pk_bf16_f32 v101, v102, v103
    buffer_store_short v100, v105, s[32:35], 0 offen
    buffer_store_short_d16_hi v100, v105, s[32:35], 0 offen offset:128
    buffer_store_short v101, v105, s[32:35], 0 offen offset:256
    buffer_store_short_d16_hi v101, v105, s[32:35], 0 offen offset:384
    s_endpgm
L_posw:
    s_setprio 1
    s_waitcnt lgkmcnt(0)
    s_barrier
    s_cmp_eq_u32 s3, 15
    s_cbranch_scc1 L_w15
    ds_read_b128 v[12:15], v106 offset:2496
    ds_read_b128 v[16:19], v106 offset:2560
    ds_read_b128 v[28:31], v107 offset:2768
    ds_read_b128 v[32:35], v107 offset:2832
    s_waitcnt lgkmcnt(1)
    v_pk_add_f32 v[12:13], v[12:13], v[28:29]
    v_pk_add_f32 v[14:15], v[14:15], v[30:31]
    s_waitcnt lgkmcnt(0)
    v_pk_add_f32 v[16:17], v[16:17], v[32:33]
    v_pk_add_f32 v[18:19], v[18:19], v[34:35]
    s_cmp_lg_u64 s[52:53], 0
    s_cbranch_scc1 L_psp
L_pdp:
    v_pk_add_f32 v[12:13], v[12:13], v[14:15]
    v_pk_add_f32 v[16:17], v[16:17], v[18:19]
    v_pk_add_f32 v[12:13], v[12:13], v[16:17]
    v_add_f32 v12, v12, v13
    v_add_f32 v12, v12, v100
    v_cvt_pk_bf16_f32 v12, v12, v12
    s_mov_b64 exec, s[54:55]
    buffer_store_short v12, v105, s[32:35], 0 offen
    s_endpgm
L_w15:
    s_cmp_lg_u32 s2, 0
    s_cbranch_scc1 L_w15e
    v_mov_b32 v110, 1568768
    v_mov_b32 v111, s39
    s_mov_b64 exec, 1
    buffer_store_dword v111, v110, s[24:27], 0 offen
L_w15e:
    s_endpgm
L_wa:
    v_and_b32 v96, 31, v3
    v_and_b32 v97, 7, v3
    v_xor_b32 v97, v97, v4
    v_lshlrev_b32 v97, 4, v97
    v_lshl_add_u32 v97, v96, 7, v97
    v_add_u32 v92, 131840, v97
    v_xor_b32 v93, 32, v92
    v_xor_b32 v94, 64, v92
    v_xor_b32 v95, 96, v92
    v_mov_b32 v97, s62
    v_mov_b32 v98, 0x1b800000
    v_cmp_gt_u32 vcc, 16, v96
    s_nop 1
    v_cndmask_b32 v97, v97, v98, vcc
    v_lshlrev_b32 v96, 2, v96
    v_lshl_add_u32 v96, v4, 9, v96
    v_add_u32 v96, 136960, v96
    s_mov_b32 s64, 0x05040100
    s_mov_b32 s65, 0x07060302
L_sp6:
    ds_read_b32 v99, v127 offset:1812
    s_waitcnt lgkmcnt(0)
    v_cmp_ne_u32 vcc, 4, v99
    s_cbranch_vccnz L_sp6
    ds_read_b128 v[12:15], v92 offset:4096
    ds_read_b128 v[16:19], v93 offset:4096
    ds_read_b128 v[20:23], v94 offset:4096
    ds_read_b128 v[24:27], v95 offset:4096
    s_waitcnt vmcnt(24)
    v_perm_b32 v28, v61, v60, s64
    v_perm_b32 v29, v63, v62, s64
    v_perm_b32 v30, v65, v64, s64
    v_perm_b32 v31, v67, v66, s64
    v_perm_b32 v32, v61, v60, s65
    v_perm_b32 v33, v63, v62, s65
    v_perm_b32 v34, v65, v64, s65
    v_perm_b32 v35, v67, v66, s65
    s_waitcnt vmcnt(16)
    v_perm_b32 v36, v69, v68, s64
    v_perm_b32 v37, v71, v70, s64
    v_perm_b32 v38, v73, v72, s64
    v_perm_b32 v39, v75, v74, s64
    v_perm_b32 v40, v69, v68, s65
    v_perm_b32 v41, v71, v70, s65
    v_perm_b32 v42, v73, v72, s65
    v_perm_b32 v43, v75, v74, s65
    s_waitcnt vmcnt(8)
    v_perm_b32 v44, v77, v76, s64
    v_perm_b32 v45, v79, v78, s64
    v_perm_b32 v46, v81, v80, s64
    v_perm_b32 v47, v83, v82, s64
    v_perm_b32 v48, v77, v76, s65
    v_perm_b32 v49, v79, v78, s65
    v_perm_b32 v50, v81, v80, s65
    v_perm_b32 v51, v83, v82, s65
    s_waitcnt vmcnt(0)
    v_perm_b32 v52, v85, v84, s64
    v_perm_b32 v53, v87, v86, s64
    v_perm_b32 v54, v89, v88, s64
    v_perm_b32 v55, v91, v90, s64
    v_perm_b32 v56, v85, v84, s65
    v_perm_b32 v57, v87, v86, s65
    v_perm_b32 v58, v89, v88, s65
    v_perm_b32 v59, v91, v90, s65
    s_waitcnt lgkmcnt(3)
    v_mfma_f32_32x32x16_bf16 v[60:75], v[12:15], v[28:31], 0
    v_mfma_f32_32x32x16_bf16 v[76:91], v[12:15], v[32:35], 0
    ds_read_b128 v[12:15], v92
    s_waitcnt lgkmcnt(3)
    v_mfma_f32_32x32x16_bf16 v[60:75], v[16:19], v[36:39], v[60:75]
    v_mfma_f32_32x32x16_bf16 v[76:91], v[16:19], v[40:43], v[76:91]
    ds_read_b128 v[16:19], v93
    s_waitcnt lgkmcnt(3)
    v_mfma_f32_32x32x16_bf16 v[60:75], v[20:23], v[44:47], v[60:75]
    v_mfma_f32_32x32x16_bf16 v[76:91], v[20:23], v[48:51], v[76:91]
    ds_read_b128 v[20:23], v94
    s_waitcnt lgkmcnt(3)
    v_mfma_f32_32x32x16_bf16 v[60:75], v[24:27], v[52:55], v[60:75]
    v_mfma_f32_32x32x16_bf16 v[76:91], v[24:27], v[56:59], v[76:91]
    ds_read_b128 v[24:27], v95
    s_nop 9
    v_mul_f32 v100, v97, v60
    v_mul_f32 v101, v97, v61
    v_mul_f32 v102, v97, v62
    v_mul_f32 v103, v97, v63
    v_mul_f32 v104, v97, v76
    v_mul_f32 v105, v97, v77
    v_mul_f32 v106, v97, v78
    v_mul_f32 v107, v97, v79
    v_cvt_pk_bf16_f32 v100, v100, v104
    v_cvt_pk_bf16_f32 v101, v101, v105
    v_cvt_pk_bf16_f32 v102, v102, v106
    v_cvt_pk_bf16_f32 v103, v103, v107
    ds_write_b32 v96, v100 offset:4096
    ds_write_b32 v96, v101 offset:4224
    ds_write_b32 v96, v102 offset:4352
    ds_write_b32 v96, v103 offset:4480
    s_waitcnt lgkmcnt(7)
    v_mfma_f32_32x32x16_bf16 v[60:75], v[12:15], v[28:31], 0
    v_mfma_f32_32x32x16_bf16 v[76:91], v[12:15], v[32:35], 0
    s_waitcnt lgkmcnt(6)
    v_mfma_f32_32x32x16_bf16 v[60:75], v[16:19], v[36:39], v[60:75]
    v_mfma_f32_32x32x16_bf16 v[76:91], v[16:19], v[40:43], v[76:91]
    s_waitcnt lgkmcnt(5)
    v_mfma_f32_32x32x16_bf16 v[60:75], v[20:23], v[44:47], v[60:75]
    v_mfma_f32_32x32x16_bf16 v[76:91], v[20:23], v[48:51], v[76:91]
    s_waitcnt lgkmcnt(4)
    v_mfma_f32_32x32x16_bf16 v[60:75], v[24:27], v[52:55], v[60:75]
    v_mfma_f32_32x32x16_bf16 v[76:91], v[24:27], v[56:59], v[76:91]
    s_nop 10
    v_mul_f32 v100, v97, v60
    v_mul_f32 v101, v97, v61
    v_mul_f32 v102, v97, v62
    v_mul_f32 v103, v97, v63
    v_mul_f32 v104, v97, v76
    v_mul_f32 v105, v97, v77
    v_mul_f32 v106, v97, v78
    v_mul_f32 v107, v97, v79
    v_cvt_pk_bf16_f32 v100, v100, v104
    v_cvt_pk_bf16_f32 v101, v101, v105
    v_cvt_pk_bf16_f32 v102, v102, v106
    v_cvt_pk_bf16_f32 v103, v103, v107
    ds_write_b32 v96, v100 offset:0
    ds_write_b32 v96, v101 offset:128
    ds_write_b32 v96, v102 offset:256
    ds_write_b32 v96, v103 offset:384
    v_mul_f32 v100, v97, v64
    v_mul_f32 v101, v97, v65
    v_mul_f32 v102, v97, v66
    v_mul_f32 v103, v97, v67
    v_mul_f32 v104, v97, v80
    v_mul_f32 v105, v97, v81
    v_mul_f32 v106, v97, v82
    v_mul_f32 v107, v97, v83
    v_cvt_pk_bf16_f32 v100, v100, v104
    v_cvt_pk_bf16_f32 v101, v101, v105
    v_cvt_pk_bf16_f32 v102, v102, v106
    v_cvt_pk_bf16_f32 v103, v103, v107
    ds_write_b32 v96, v100 offset:1024
    ds_write_b32 v96, v101 offset:1152
    ds_write_b32 v96, v102 offset:1280
    ds_write_b32 v96, v103 offset:1408
    v_mul_f32 v100, v97, v68
    v_mul_f32 v101, v97, v69
    v_mul_f32 v102, v97, v70
    v_mul_f32 v103, v97, v71
    v_mul_f32 v104, v97, v84
    v_mul_f32 v105, v97, v85
    v_mul_f32 v106, v97, v86
    v_mul_f32 v107, v97, v87
    v_cvt_pk_bf16_f32 v100, v100, v104
    v_cvt_pk_bf16_f32 v101, v101, v105
    v_cvt_pk_bf16_f32 v102, v102, v106
    v_cvt_pk_bf16_f32 v103, v103, v107
    ds_write_b32 v96, v100 offset:2048
    ds_write_b32 v96, v101 offset:2176
    ds_write_b32 v96, v102 offset:2304
    ds_write_b32 v96, v103 offset:2432
    v_mul_f32 v100, v97, v72
    v_mul_f32 v101, v97, v73
    v_mul_f32 v102, v97, v74
    v_mul_f32 v103, v97, v75
    v_mul_f32 v104, v97, v88
    v_mul_f32 v105, v97, v89
    v_mul_f32 v106, v97, v90
    v_mul_f32 v107, v97, v91
    v_cvt_pk_bf16_f32 v100, v100, v104
    v_cvt_pk_bf16_f32 v101, v101, v105
    v_cvt_pk_bf16_f32 v102, v102, v106
    v_cvt_pk_bf16_f32 v103, v103, v107
    ds_write_b32 v96, v100 offset:3072
    ds_write_b32 v96, v101 offset:3200
    ds_write_b32 v96, v102 offset:3328
    ds_write_b32 v96, v103 offset:3456
    s_branch L_w4
L_slow:
    s_waitcnt vmcnt(0) lgkmcnt(0)
    s_load_dwordx2 s[28:29], s[0:1], 40
    s_mov_b32 s38, 0
    s_mov_b32 s40, s3
    v_lshlrev_b32 v12, 1, v3
    v_cmp_gt_u32 s[42:43], 32, v3
    v_mov_b32 v13, 1.0
    v_mov_b32 v14, 0x63b8aa3b
    v_cndmask_b32 v13, v13, v14, s[42:43]
    v_and_b32 v14, 31, v3
    v_lshlrev_b32 v14, 2, v14
    v_lshlrev_b32 v15, 2, v3
    s_waitcnt lgkmcnt(0)
    s_add_u32 s28, s28, 16384
    s_addc_u32 s29, s29, 0
    global_load_ushort v16, v12, s[28:29]
    global_load_ushort v17, v12, s[28:29] offset:128
    v_add_u32 v18, 143616, v15
    ds_read_b32 v18, v18
    s_waitcnt vmcnt(1)
    v_lshlrev_b32 v16, 16, v16
    s_waitcnt vmcnt(0)
    v_lshlrev_b32 v17, 16, v17
    v_mul_f32 v16, s62, v16
    v_mul_f32 v17, s62, v17
    s_lshl_b32 s56, s16, 2
    s_add_u32 s56, s56, 1572864
    s_waitcnt vmcnt(0) lgkmcnt(0)
L_sn:
    s_cmp_ge_u32 s40, s18
    s_cbranch_scc1 L_sdone
    s_add_u32 s41, s17, s40
    s_and_b32 s44, s41, 63
    s_lshl_b32 s44, s44, 4
    s_mul_i32 s45, s41, 6
    v_mov_b32 v19, s45
    buffer_load_ushort v23, v19, s[8:11], 0 offen
    buffer_load_ushort v24, v19, s[8:11], 0 offen offset:2
    buffer_load_ushort v25, v19, s[8:11], 0 offen offset:4
    s_lshl_b32 s45, s40, 7
    s_add_u32 s45, s45, 136960
    v_add_u32 v20, s45, v12
    ds_read_u16 v22, v20
    s_waitcnt vmcnt(2)
    v_lshlrev_b32 v23, 16, v23
    s_waitcnt vmcnt(1)
    v_lshlrev_b32 v24, 16, v24
    s_waitcnt vmcnt(0)
    v_lshlrev_b32 v25, 16, v25
    s_waitcnt lgkmcnt(0)
    v_lshlrev_b32 v22, 16, v22
    v_mov_b32 v26, 0
    v_mov_b32 v27, 0
    v_mov_b32 v28, 0
    v_mov_b32 v29, 0
    s_mov_b32 s46, 0
L_sc:
    s_lshl_b32 s47, s46, 10
    v_mov_b32 v19, s47
    buffer_load_dwordx2 v[30:31], v19, s[24:27], s56 offen sc1
    s_waitcnt vmcnt(0)
    v_readfirstlane_b32 s47, v30
    v_readfirstlane_b32 s48, v31
    s_and_b32 s49, s39, 0xffc08007
    s_or_b32 s49, s49, 20000
    s_cmp_eq_u32 s16, 255
    s_cselect_b32 s48, s49, s48
    s_xor_b32 s49, s47, s39
    s_xor_b32 s50, s48, s39
    s_or_b32 s49, s49, s50
    s_and_b32 s49, s49, 0xffc08007
    s_cbranch_scc0 L_sd
    s_sub_u32 s59, s59, 1
    s_cmp_gt_i32 s59, 0
    s_cbranch_scc1 L_sc
    s_mov_b32 s48, s47
L_sd:
    s_and_b32 s47, s47, 0x7ff8
    s_and_b32 s48, s48, 0x7ff8
    s_sub_u32 s48, s48, s47
    s_mul_i32 s49, s46, 20480
    s_add_u32 s49, s49, 1900544
    s_add_u32 s49, s49, s47
    s_mov_b32 s50, 0
L_sb:
    s_cmp_ge_u32 s50, s48
    s_cbranch_scc1 L_sbe
    v_lshl_add_u32 v19, v3, 3, s50
    buffer_load_dwordx2 v[30:31], v19, s[24:27], s49 offen sc1
    v_cmp_gt_u32 s[52:53], s48, v19
    s_waitcnt vmcnt(0)
    v_xor_b32 v30, s70, v30
    v_xor_b32 v31, s71, v31
    v_and_b32 v32, s34, v30
    v_and_or_b32 v32, v31, s35, v32
    v_cmp_eq_u32 vcc, 0, v32
    s_nop 0
    s_andn2_b64 s[64:65], s[52:53], vcc
    s_cbranch_scc0 L_sv
    s_sub_u32 s59, s59, 1
    s_cmp_gt_i32 s59, 0
    s_cbranch_scc1 L_sb
    s_and_b64 s[52:53], s[52:53], vcc
L_sv:
    v_and_b32 v32, 0xffff, v30
    v_cmp_eq_u32 vcc, s44, v32
    s_nop 0
    s_and_b64 s[52:53], s[52:53], vcc
L_se:
    s_cmp_eq_u64 s[52:53], 0
    s_cbranch_scc1 L_see
    s_ff1_i32_b64 s51, s[52:53]
    s_bitset0_b64 s[52:53], s51
    v_readlane_b32 s54, v30, s51
    v_readlane_b32 s55, v31, s51
    s_and_b32 s54, s54, 0xffff0000
    s_lshr_b32 s57, s55, 1
    s_add_u32 s57, s57, s55
    s_lshl_b32 s55, s55, 5
    v_mov_b32 v33, s57
    v_add_u32 v36, s55, v14
    buffer_load_ushort v37, v33, s[8:11], 0 offen
    buffer_load_ushort v38, v33, s[8:11], 0 offen offset:2
    buffer_load_ushort v39, v33, s[8:11], 0 offen offset:4
    buffer_load_dword v36, v36, s[24:27], 0 offen sc1
    s_waitcnt vmcnt(3)
    v_lshlrev_b32 v37, 16, v37
    s_waitcnt vmcnt(2)
    v_lshlrev_b32 v38, 16, v38
    s_waitcnt vmcnt(1)
    v_lshlrev_b32 v39, 16, v39
    v_sub_f32 v37, v23, v37
    v_sub_f32 v38, v24, v38
    v_sub_f32 v39, v25, v39
    v_cvt_pk_bf16_f32 v40, 1.0, v37
    v_mul_f32 v37, v37, v37
    v_cvt_pk_bf16_f32 v41, v38, v39
    v_dot2_f32_bf16 v37, v41, v41, v37
    s_nop 2
    v_cvt_pk_bf16_f32 v37, 0, v37
    s_waitcnt vmcnt(0)
    v_lshlrev_b32 v42, 16, v36
    v_cndmask_b32 v36, v36, v42, s[42:43]
    v_add_f32 v36, v36, v22
    v_mul_f32 v36, v36, v13
    v_fmac_f32 v36, v37, v16
    v_fmac_f32 v36, s54, v17
    v_exp_f32 v42, -v36
    s_nop 0
    v_add_f32 v42, 1.0, v42
    v_rcp_f32 v42, v42
    s_nop 0
    v_mul_f32 v36, v36, v42
    v_and_b32 v40, 0xffff0000, v40
    v_lshlrev_b32 v42, 16, v41
    v_and_b32 v41, 0xffff0000, v41
    v_add_f32 v26, v26, v36
    v_fmac_f32 v27, v36, v40
    v_fmac_f32 v28, v36, v42
    v_fmac_f32 v29, v36, v41
    s_branch L_se
L_see:
    s_add_u32 s50, s50, 512
    s_branch L_sb
L_sbe:
    s_add_u32 s46, s46, 1
    s_cmp_lt_u32 s46, 256
    s_cbranch_scc1 L_sc
    s_nop 4
    v_mul_f32 v27, v27, v18
    v_mul_f32 v28, v28, v18
    v_mul_f32 v29, v29, v18
    v_add_f32_dpp v27, v27, v27 row_ror:8 row_mask:0xf bank_mask:0xf
    s_nop 0
    v_add_f32_dpp v29, v29, v29 row_ror:8 row_mask:0xf bank_mask:0xf
    v_add_f32_dpp v27, v28, v28 row_ror:8 row_mask:0xf bank_mask:0xc
    s_nop 1
    v_add_f32_dpp v27, v27, v27 row_shl:4 row_mask:0xf bank_mask:0x5
    s_nop 1
    v_add_f32_dpp v27, v29, v29 row_shr:4 row_mask:0xf bank_mask:0x2
    v_mov_b32 v28, v27
    v_mov_b32 v29, v26
    s_nop 0
    v_permlane32_swap_b32 v27, v28
    v_permlane32_swap_b32 v26, v29
    v_add_f32 v27, v27, v28
    v_cvt_pk_bf16_f32 v26, v26, v29
    s_mul_i32 s45, s40, 272
    s_add_u32 s45, s45, 2368
    v_add_u32 v19, s45, v14
    ds_write2_b32 v19, v26, v27 offset0:0 offset1:32
    s_lshl_b32 s45, s40, 2
    v_mov_b32 v19, s45
    v_mov_b32 v20, 1
    ds_write_b32 v19, v20 offset:1536
    s_add_u32 s40, s40, 16
    s_waitcnt lgkmcnt(0)
    s_branch L_sn
L_sdone:
    s_barrier
    s_branch L_prep
L_end:
    s_endpgm
.section .rodata,"a"
.p2align 6
.amdhsa_kernel standalone__cheap_equivariant_egnn__graph_kernel
  .amdhsa_next_free_vgpr 128
  .amdhsa_next_free_sgpr 96
  .amdhsa_accum_offset 128
  .amdhsa_group_segment_fixed_size 0
  .amdhsa_kernarg_size 88
  .amdhsa_user_sgpr_count 2
  .amdhsa_user_sgpr_kernarg_segment_ptr 1
  .amdhsa_system_sgpr_workgroup_id_x 1
  .amdhsa_float_denorm_mode_32 3
.end_amdhsa_kernel
```
